```python
import torch

def _softmax(x, axis=-1):
    return torch.softmax(x, dim=axis)
def _gelu(x):
    return torch.nn.functional.gelu(x, approximate="tanh")
def _silu(x):
    return torch.nn.functional.silu(x)
def _sigmoid(x):
    return torch.sigmoid(x)
def _layernorm(x, axis=-1, eps=1e-5):
    m = x.mean(dim=axis, keepdim=True)
    v = x.var(dim=axis, keepdim=True, unbiased=False)
    return (x - m) / torch.sqrt(v + eps)
def _scatter_add(tgt, idx, src, axis=0):
    return tgt.clone().index_add_(axis, idx, src)
def _segment_sum(src, seg, n):
    out = torch.zeros((n,) + src.shape[1:], dtype=src.dtype)
    return out.index_add_(0, seg, src)
def _pad(x, pw):
    flat = tuple(v for pair in reversed(pw) for v in pair)
    return torch.nn.functional.pad(x, flat)

kernel_name = 'sequential_preLN__gqa_block_cached__dense_activation_gelu__decode'

def setup_inputs():

    _w = (lambda a: (lambda t: t.to(torch.bfloat16) if t.is_floating_point() else t)(torch.as_tensor(a)))
    def _A_setup():
        B, Sq, D = 2, 1, 512
        Hq, Hkv, Sk, Dh = 32, 8, 32768, 128
        assert Hq % Hkv == 0, (Hq, Hkv)
        return {
            "x": _w((lambda *s: torch.randn(*s, dtype=torch.bfloat16) * 0.1)(B, Sq, D)),
            "k_cache": _w((lambda *s: torch.randn(*s, dtype=torch.bfloat16) * 1.6)(B, Hkv, Sk, Dh)),
            "v_cache": _w((lambda *s: torch.randn(*s, dtype=torch.bfloat16) * 1.6)(B, Hkv, Sk, Dh)),
            "wq": _w((lambda *s: torch.randn(*s, dtype=torch.bfloat16) * 1.6)(D, Hq * Dh) * (D ** -0.5)),
            "wo": _w((lambda *s: torch.randn(*s, dtype=torch.bfloat16) * 1.6)(Hq * Dh, D) * ((Hq * Dh) ** -0.5)),
        }
    _A_in = _A_setup()

    def _B_setup():
        B, S, D, F = 2, 1, 512, 1792
        return {
            "x": _w((lambda *s: torch.randn(*s, dtype=torch.bfloat16) * 0.1)(B, S, D)),
            "w1": _w((lambda *s: torch.randn(*s, dtype=torch.bfloat16) * 3.2)(D, F) * (D ** -0.5)),
            "b1": _w((lambda *s: torch.randn(*s, dtype=torch.bfloat16) * 3.2)(F) * 0.01),
            "w2": _w((lambda *s: torch.randn(*s, dtype=torch.bfloat16) * 3.2)(F, D) * (F ** -0.5)),
            "b2": _w((lambda *s: torch.randn(*s, dtype=torch.bfloat16) * 3.2)(D) * 0.01),
        }
    _B_in = _B_setup()

    return {
        "A_x": _A_in["x"],
        "A_k_cache": _A_in["k_cache"],
        "A_v_cache": _A_in["v_cache"],
        "A_wq": _A_in["wq"],
        "A_wo": _A_in["wo"],
        "B_x": _B_in["x"],
        "B_w1": _B_in["w1"],
        "B_b1": _B_in["b1"],
        "B_w2": _B_in["w2"],
        "B_b2": _B_in["b2"],
    }

def reference(A_x, A_k_cache, A_v_cache, A_wq, A_wo, B_x, B_w1, B_b1, B_w2, B_b2):
    def _A_ref(x, k_cache, v_cache, wq, wo):
        B, Sq, D = x.shape
        Hq, Dh = 32, 128
        Hkv = k_cache.shape[1]
        rep = Hq // Hkv
        q = (lambda x, *d: x.permute(*d))((x @ wq).reshape(B, Sq, Hq, Dh), 0, 2, 1, 3)
        k = (lambda x, n, axis: torch.repeat_interleave(x, n, dim=axis))(k_cache, rep, axis=1)
        v = (lambda x, n, axis: torch.repeat_interleave(x, n, dim=axis))(v_cache, rep, axis=1)
        scores = torch.einsum("bhqd,bhkd->bhqk", q, k) * (Dh ** -0.5)
        p = _softmax(scores, axis=-1)
        o = torch.einsum("bhqk,bhkd->bhqd", p, v)
        return (lambda x, *d: x.permute(*d))(o, 0, 2, 1, 3).reshape(B, Sq, Hq * Dh) @ wo

    def _B_ref(x, w1, b1, w2, b2):
        h = torch.einsum("bsd,df->bsf", x, w1) + b1
        h = _gelu(h)
        return torch.einsum("bsf,fd->bsd", h, w2) + b2

    x = A_x
    h = x + _A_ref(_layernorm(x, axis=-1), A_k_cache, A_v_cache, A_wq, A_wo)
    h2 = h + _B_ref(_layernorm(h, axis=-1), B_w1, B_b1, B_w2, B_b2)
    return h2
```

```asm
; @launch grid=(256,1,1) block=(512,1,1) lds=131072
.amdgcn_target "amdgcn-amd-amdhsa--gfx950"
.text
.globl sequential_preLN__gqa_block_cached__dense_activation_gelu__decode_kernel
.p2align 8
.type sequential_preLN__gqa_block_cached__dense_activation_gelu__decode_kernel,@function
sequential_preLN__gqa_block_cached__dense_activation_gelu__decode_kernel:
    s_cmp_ge_u32 s2, 256
    s_cbranch_scc1 Lend
    s_load_dwordx16 s[16:31], s[0:1], 0
    s_load_dwordx8 s[32:39], s[0:1], 64
    s_load_dwordx2 s[40:41], s[0:1], 96
    v_lshrrev_b32 v5, 6, v0
    v_and_b32 v0, 63, v0
    v_readfirstlane_b32 s3, v5
    v_and_b32 v5, 3, v0
    v_lshlrev_b32 v5, 2, v5
    v_bfe_u32 v6, v0, 2, 1
    v_add_u32 v5, v5, v6
    v_lshlrev_b32 v5, 8, v5
    v_lshrrev_b32 v6, 4, v0
    v_lshl_add_u32 v5, v6, 4, v5
    v_bfe_u32 v6, v0, 3, 1
    v_lshl_add_u32 v1, v6, 6, v5
    v_xor_b32 v6, 1, v6
    v_lshl_add_u32 v122, v6, 6, v5
    v_add_u32 v122, 512, v122
    v_add_u32 v2, 0x1000, v1
    v_add_u32 v123, 0x1000, v122
    v_lshlrev_b32 v3, 4, v0
    v_add_u32 v4, 0x1000, v3
    s_lshr_b32 s59, s2, 4
    s_and_b32 s60, s2, 15
    s_and_b32 s61, s59, 7
    s_lshr_b32 s62, s59, 3
    s_mov_b32 s56, 0x3e0293ee
    s_mov_b32 s57, 0x05040100
    s_mov_b32 s58, 0x07060302
    s_mov_b32 s70, 0
    s_lshl_b32 s65, s3, 13
    v_lshrrev_b32 v5, 3, v0
    v_lshlrev_b32 v5, 13, v5
    v_and_b32 v6, 7, v0
    v_lshl_add_u32 v5, v6, 4, v5
    s_and_b32 s42, s2, 3
    s_lshl_b32 s42, s42, 7
    s_lshl_b32 s43, s3, 4
    s_add_u32 s42, s42, s43
    s_lshl_b32 s42, s42, 13
    s_lshr_b32 s43, s2, 2
    s_lshl_b32 s43, s43, 7
    s_add_u32 s66, s42, s43
    s_lshl_b32 s67, s3, 11
    s_lshl_b32 s68, s2, 19
    s_waitcnt lgkmcnt(0)
    s_load_dword s52, s[40:41], 0
    s_mov_b32 s44, s22
    s_mov_b32 s45, s23
    s_mov_b32 s46, 4194304
    s_mov_b32 s47, 0x20000
    s_cmp_eq_u32 s3, 0
    s_cbranch_scc0 Lnox
    s_mov_b32 s48, s16
    s_mov_b32 s49, s17
    s_mov_b32 s50, 2048
    s_mov_b32 s51, 0x20000
    buffer_load_dwordx4 v[96:99], v3, s[48:51], 0 offen
    buffer_load_dwordx4 v[100:103], v3, s[48:51], 0 offen offset:1024
Lnox:
    s_add_u32 s43, s67, 0
    s_mov_b32 m0, s43
    s_add_u32 s42, s66, 0
    buffer_load_dwordx4 v5, s[44:47], s42 offen nt lds
    s_add_u32 s43, s67, 1024
    s_mov_b32 m0, s43
    s_add_u32 s42, s66, 65536
    buffer_load_dwordx4 v5, s[44:47], s42 offen nt lds
    s_add_u32 s4, s18, s68
    s_addc_u32 s5, s19, 0
    s_mov_b32 s6, 0x80000
    s_mov_b32 s7, 0x20000
    s_add_u32 s8, s20, s68
    s_addc_u32 s9, s21, 0
    s_mov_b32 s10, 0x80000
    s_mov_b32 s11, 0x20000
    s_mov_b32 s12, s40
    s_mov_b32 s13, s41
    s_mov_b32 s14, 0x140000
    s_mov_b32 s15, 0x20000
    s_add_u32 s42, s65, 0
    buffer_load_dwordx4 v[128:131], v1, s[4:7], s42 offen offset:0 nt
    buffer_load_dwordx4 v[132:135], v1, s[4:7], s42 offen offset:128 nt
    buffer_load_dwordx4 v[136:139], v122, s[4:7], s42 offen offset:0 nt
    buffer_load_dwordx4 v[140:143], v122, s[4:7], s42 offen offset:128 nt
    buffer_load_dwordx4 v[144:147], v2, s[4:7], s42 offen offset:0 nt
    buffer_load_dwordx4 v[148:151], v2, s[4:7], s42 offen offset:128 nt
    buffer_load_dwordx4 v[152:155], v123, s[4:7], s42 offen offset:0 nt
    buffer_load_dwordx4 v[156:159], v123, s[4:7], s42 offen offset:128 nt
    s_cmp_eq_u32 s3, 0
    s_cbranch_scc0 Lnoinit
    v_mov_b32 v8, 23680
    v_mov_b32 v9, 0
    ds_write_b32 v8, v9
    ds_write_b32 v8, v9 offset:32
    v_lshlrev_b32 v8, 2, v0
    v_add_u32 v8, 23808, v8
    ds_write_b32 v8, v9
Lnoinit:
    s_waitcnt lgkmcnt(0)
    s_barrier
    s_waitcnt vmcnt(8)
    v_mov_b32 v6, 23712
    v_mov_b32 v7, 1
    s_mov_b64 exec, 1
    ds_add_u32 v6, v7
    s_mov_b64 exec, -1
    s_cmp_eq_u32 s3, 0
    s_cbranch_scc1 Lwave0
    s_add_u32 s42, s65, 65536
    buffer_load_dwordx4 v[160:163], v1, s[4:7], s42 offen offset:0 nt
    buffer_load_dwordx4 v[164:167], v1, s[4:7], s42 offen offset:128 nt
    buffer_load_dwordx4 v[168:171], v122, s[4:7], s42 offen offset:0 nt
    buffer_load_dwordx4 v[172:175], v122, s[4:7], s42 offen offset:128 nt
    buffer_load_dwordx4 v[176:179], v2, s[4:7], s42 offen offset:0 nt
    buffer_load_dwordx4 v[180:183], v2, s[4:7], s42 offen offset:128 nt
    buffer_load_dwordx4 v[184:187], v123, s[4:7], s42 offen offset:0 nt
    buffer_load_dwordx4 v[188:191], v123, s[4:7], s42 offen offset:128 nt
    s_add_u32 s42, s65, 131072
    buffer_load_dwordx4 v[192:195], v1, s[4:7], s42 offen offset:0 nt
    buffer_load_dwordx4 v[196:199], v1, s[4:7], s42 offen offset:128 nt
    buffer_load_dwordx4 v[200:203], v122, s[4:7], s42 offen offset:0 nt
    buffer_load_dwordx4 v[204:207], v122, s[4:7], s42 offen offset:128 nt
    buffer_load_dwordx4 v[208:211], v2, s[4:7], s42 offen offset:0 nt
    buffer_load_dwordx4 v[212:215], v2, s[4:7], s42 offen offset:128 nt
    buffer_load_dwordx4 v[216:219], v123, s[4:7], s42 offen offset:0 nt
    buffer_load_dwordx4 v[220:223], v123, s[4:7], s42 offen offset:128 nt
    s_waitcnt lgkmcnt(0)
    s_add_u32 s52, s52, 1
    s_and_b32 s53, s52, 0xff
    s_mul_i32 s53, s53, 0x01010101
    s_barrier
    s_add_u32 s42, s65, 196608
    buffer_load_dwordx4 v[224:227], v1, s[4:7], s42 offen offset:0 nt
    buffer_load_dwordx4 v[228:231], v1, s[4:7], s42 offen offset:128 nt
    buffer_load_dwordx4 v[232:235], v122, s[4:7], s42 offen offset:0 nt
    buffer_load_dwordx4 v[236:239], v122, s[4:7], s42 offen offset:128 nt
    buffer_load_dwordx4 v[240:243], v2, s[4:7], s42 offen offset:0 nt
    buffer_load_dwordx4 v[244:247], v2, s[4:7], s42 offen offset:128 nt
    buffer_load_dwordx4 v[248:251], v123, s[4:7], s42 offen offset:0 nt
    buffer_load_dwordx4 v[252:255], v123, s[4:7], s42 offen offset:128 nt
    s_branch Lqread
Lwave0:
    v_add_u32 v8, 16896, v3
    ds_write_b128 v8, v[96:99]
    ds_write_b128 v8, v[100:103] offset:1088
    v_lshlrev_b32 v10, 16, v96
    v_and_b32 v11, 0xffff0000, v96
    v_add_f32 v112, v10, v11
    v_mul_f32 v113, v10, v10
    v_fmac_f32 v113, v11, v11
    v_lshlrev_b32 v10, 16, v97
    v_and_b32 v11, 0xffff0000, v97
    v_add_f32 v112, v112, v10
    v_fmac_f32 v113, v10, v10
    v_add_f32 v112, v112, v11
    v_fmac_f32 v113, v11, v11
    v_lshlrev_b32 v10, 16, v98
    v_and_b32 v11, 0xffff0000, v98
    v_add_f32 v112, v112, v10
    v_fmac_f32 v113, v10, v10
    v_add_f32 v112, v112, v11
    v_fmac_f32 v113, v11, v11
    v_lshlrev_b32 v10, 16, v99
    v_and_b32 v11, 0xffff0000, v99
    v_add_f32 v112, v112, v10
    v_fmac_f32 v113, v10, v10
    v_add_f32 v112, v112, v11
    v_fmac_f32 v113, v11, v11
    v_lshlrev_b32 v10, 16, v100
    v_and_b32 v11, 0xffff0000, v100
    v_add_f32 v114, v10, v11
    v_mul_f32 v115, v10, v10
    v_fmac_f32 v115, v11, v11
    v_lshlrev_b32 v10, 16, v101
    v_and_b32 v11, 0xffff0000, v101
    v_add_f32 v114, v114, v10
    v_fmac_f32 v115, v10, v10
    v_add_f32 v114, v114, v11
    v_fmac_f32 v115, v11, v11
    v_lshlrev_b32 v10, 16, v102
    v_and_b32 v11, 0xffff0000, v102
    v_add_f32 v114, v114, v10
    v_fmac_f32 v115, v10, v10
    v_add_f32 v114, v114, v11
    v_fmac_f32 v115, v11, v11
    v_lshlrev_b32 v10, 16, v103
    v_and_b32 v11, 0xffff0000, v103
    v_add_f32 v114, v114, v10
    v_fmac_f32 v115, v10, v10
    v_add_f32 v114, v114, v11
    v_fmac_f32 v115, v11, v11
    v_and_b32 v8, 1, v0
    v_mul_u32_u24 v8, 1088, v8
    v_lshrrev_b32 v9, 4, v0
    v_lshl_add_u32 v8, v9, 4, v8
    s_and_b32 s42, s2, 3
    s_lshl_b32 s42, s42, 8
    s_add_u32 s42, s42, 16896
    v_add_u32 v8, s42, v8
    v_bfe_u32 v10, v0, 2, 2
    v_lshl_add_u32 v10, v9, 3, v10
    v_lshlrev_b32 v10, 7, v10
    v_and_b32 v11, 3, v0
    v_lshl_add_u32 v9, v11, 3, v10
    v_add_f32_dpp v112, v112, v112 row_ror:8 row_mask:0xf bank_mask:0xf
    v_add_f32_dpp v113, v113, v113 row_ror:8 row_mask:0xf bank_mask:0xf
    v_add_f32_dpp v114, v114, v114 row_ror:8 row_mask:0xf bank_mask:0xf
    v_add_f32_dpp v115, v115, v115 row_ror:8 row_mask:0xf bank_mask:0xf
    v_add_f32_dpp v112, v112, v112 row_ror:4 row_mask:0xf bank_mask:0xf
    v_add_f32_dpp v113, v113, v113 row_ror:4 row_mask:0xf bank_mask:0xf
    v_add_f32_dpp v114, v114, v114 row_ror:4 row_mask:0xf bank_mask:0xf
    v_add_f32_dpp v115, v115, v115 row_ror:4 row_mask:0xf bank_mask:0xf
    v_add_f32_dpp v112, v112, v112 row_ror:2 row_mask:0xf bank_mask:0xf
    v_add_f32_dpp v113, v113, v113 row_ror:2 row_mask:0xf bank_mask:0xf
    v_add_f32_dpp v114, v114, v114 row_ror:2 row_mask:0xf bank_mask:0xf
    v_add_f32_dpp v115, v115, v115 row_ror:2 row_mask:0xf bank_mask:0xf
    v_add_f32_dpp v112, v112, v112 row_ror:1 row_mask:0xf bank_mask:0xf
    v_add_f32_dpp v113, v113, v113 row_ror:1 row_mask:0xf bank_mask:0xf
    v_add_f32_dpp v114, v114, v114 row_ror:1 row_mask:0xf bank_mask:0xf
    v_add_f32_dpp v115, v115, v115 row_ror:1 row_mask:0xf bank_mask:0xf
    v_mov_b32 v10, v112
    v_mov_b32 v11, v113
    v_mov_b32 v12, v114
    v_mov_b32 v13, v115
    s_nop 0
    v_permlane16_swap_b32 v10, v112
    v_permlane16_swap_b32 v11, v113
    v_permlane16_swap_b32 v12, v114
    v_permlane16_swap_b32 v13, v115
    s_nop 0
    v_add_f32 v112, v112, v10
    v_add_f32 v113, v113, v11
    v_add_f32 v114, v114, v12
    v_add_f32 v115, v115, v13
    v_mov_b32 v10, v112
    v_mov_b32 v11, v113
    v_mov_b32 v12, v114
    v_mov_b32 v13, v115
    s_nop 0
    v_permlane32_swap_b32 v10, v112
    v_permlane32_swap_b32 v11, v113
    v_permlane32_swap_b32 v12, v114
    v_permlane32_swap_b32 v13, v115
    s_nop 0
    v_add_f32 v112, v112, v10
    v_add_f32 v113, v113, v11
    v_add_f32 v114, v114, v12
    v_add_f32 v115, v115, v13
    s_waitcnt lgkmcnt(0)
    ds_read_b128 v[64:67], v8 offset:0
    ds_read_b128 v[68:71], v8 offset:64
    ds_read_b128 v[72:75], v8 offset:128
    ds_read_b128 v[76:79], v8 offset:192
    s_mov_b32 s42, 0x3b000000
    s_mov_b32 s43, 0x3727c5ac
    v_mul_f32 v112, s42, v112
    v_mul_f32 v113, s42, v113
    v_fma_f32 v113, -v112, v112, v113
    v_max_f32 v113, 0, v113
    v_add_f32 v113, s43, v113
    v_rsq_f32 v113, v113
    v_mul_f32 v114, s42, v114
    v_mul_f32 v115, s42, v115
    v_fma_f32 v115, -v114, v114, v115
    v_max_f32 v115, 0, v115
    v_add_f32 v115, s43, v115
    v_rsq_f32 v115, v115
    v_mov_b32 v116, 0x3f803f80
    v_mov_b32 v117, 0x3f803f80
    v_mov_b32 v118, 0x3f803f80
    v_mov_b32 v119, 0x3f803f80
    v_mov_b32 v6, 23712
Lslab:
    ds_read_b32 v7, v6
    s_waitcnt lgkmcnt(0)
    v_readfirstlane_b32 s42, v7
    s_nop 0
    s_cmp_ge_u32 s42, 8
    s_cbranch_scc1 Lslabok
    s_add_u32 s70, s70, 1
    s_cmp_lt_u32 s70, 2097152
    s_cbranch_scc1 Lslab
Lslabok:
    s_mov_b32 s70, 0
    ds_read_b64_tr_b16 v[16:17], v9 offset:0
    ds_read_b64_tr_b16 v[18:19], v9 offset:512
    ds_read_b64_tr_b16 v[20:21], v9 offset:4096
    ds_read_b64_tr_b16 v[22:23], v9 offset:4608
    ds_read_b64_tr_b16 v[24:25], v9 offset:8192
    ds_read_b64_tr_b16 v[26:27], v9 offset:8704
    ds_read_b64_tr_b16 v[28:29], v9 offset:12288
    ds_read_b64_tr_b16 v[30:31], v9 offset:12800
    ds_read_b64_tr_b16 v[96:97], v9 offset:32
    ds_read_b64_tr_b16 v[98:99], v9 offset:544
    ds_read_b64_tr_b16 v[100:101], v9 offset:4128
    ds_read_b64_tr_b16 v[102:103], v9 offset:4640
    ds_read_b64_tr_b16 v[104:105], v9 offset:8224
    ds_read_b64_tr_b16 v[106:107], v9 offset:8736
    ds_read_b64_tr_b16 v[108:109], v9 offset:12320
    ds_read_b64_tr_b16 v[110:111], v9 offset:12832
    s_waitcnt lgkmcnt(8)
    v_mfma_f32_16x16x32_bf16 v[32:35], v[64:67], v[16:19], 0
    v_mfma_f32_16x16x32_bf16 v[48:51], v[116:119], v[16:19], 0
    v_mfma_f32_16x16x32_bf16 v[32:35], v[68:71], v[20:23], v[32:35]
    v_mfma_f32_16x16x32_bf16 v[48:51], v[116:119], v[20:23], v[48:51]
    v_mfma_f32_16x16x32_bf16 v[32:35], v[72:75], v[24:27], v[32:35]
    v_mfma_f32_16x16x32_bf16 v[48:51], v[116:119], v[24:27], v[48:51]
    v_mfma_f32_16x16x32_bf16 v[32:35], v[76:79], v[28:31], v[32:35]
    v_mfma_f32_16x16x32_bf16 v[48:51], v[116:119], v[28:31], v[48:51]
    ds_read_b64_tr_b16 v[16:17], v9 offset:64
    ds_read_b64_tr_b16 v[18:19], v9 offset:576
    ds_read_b64_tr_b16 v[20:21], v9 offset:4160
    ds_read_b64_tr_b16 v[22:23], v9 offset:4672
    ds_read_b64_tr_b16 v[24:25], v9 offset:8256
    ds_read_b64_tr_b16 v[26:27], v9 offset:8768
    ds_read_b64_tr_b16 v[28:29], v9 offset:12352
    ds_read_b64_tr_b16 v[30:31], v9 offset:12864
    s_waitcnt lgkmcnt(8)
    v_mfma_f32_16x16x32_bf16 v[36:39], v[64:67], v[96:99], 0
    v_mfma_f32_16x16x32_bf16 v[52:55], v[116:119], v[96:99], 0
    v_mfma_f32_16x16x32_bf16 v[36:39], v[68:71], v[100:103], v[36:39]
    v_mfma_f32_16x16x32_bf16 v[52:55], v[116:119], v[100:103], v[52:55]
    v_mfma_f32_16x16x32_bf16 v[36:39], v[72:75], v[104:107], v[36:39]
    v_mfma_f32_16x16x32_bf16 v[52:55], v[116:119], v[104:107], v[52:55]
    v_mfma_f32_16x16x32_bf16 v[36:39], v[76:79], v[108:111], v[36:39]
    v_mfma_f32_16x16x32_bf16 v[52:55], v[116:119], v[108:111], v[52:55]
    ds_read_b64_tr_b16 v[96:97], v9 offset:96
    ds_read_b64_tr_b16 v[98:99], v9 offset:608
    ds_read_b64_tr_b16 v[100:101], v9 offset:4192
    ds_read_b64_tr_b16 v[102:103], v9 offset:4704
    ds_read_b64_tr_b16 v[104:105], v9 offset:8288
    ds_read_b64_tr_b16 v[106:107], v9 offset:8800
    ds_read_b64_tr_b16 v[108:109], v9 offset:12384
    ds_read_b64_tr_b16 v[110:111], v9 offset:12896
    s_waitcnt lgkmcnt(8)
    v_mfma_f32_16x16x32_bf16 v[40:43], v[64:67], v[16:19], 0
    v_mfma_f32_16x16x32_bf16 v[56:59], v[116:119], v[16:19], 0
    v_mfma_f32_16x16x32_bf16 v[40:43], v[68:71], v[20:23], v[40:43]
    v_mfma_f32_16x16x32_bf16 v[56:59], v[116:119], v[20:23], v[56:59]
    v_mfma_f32_16x16x32_bf16 v[40:43], v[72:75], v[24:27], v[40:43]
    v_mfma_f32_16x16x32_bf16 v[56:59], v[116:119], v[24:27], v[56:59]
    v_mfma_f32_16x16x32_bf16 v[40:43], v[76:79], v[28:31], v[40:43]
    v_mfma_f32_16x16x32_bf16 v[56:59], v[116:119], v[28:31], v[56:59]
    s_waitcnt lgkmcnt(0)
    v_mfma_f32_16x16x32_bf16 v[44:47], v[64:67], v[96:99], 0
    v_mfma_f32_16x16x32_bf16 v[60:63], v[116:119], v[96:99], 0
    v_mfma_f32_16x16x32_bf16 v[44:47], v[68:71], v[100:103], v[44:47]
    v_mfma_f32_16x16x32_bf16 v[60:63], v[116:119], v[100:103], v[60:63]
    v_mfma_f32_16x16x32_bf16 v[44:47], v[72:75], v[104:107], v[44:47]
    v_mfma_f32_16x16x32_bf16 v[60:63], v[116:119], v[104:107], v[60:63]
    v_mfma_f32_16x16x32_bf16 v[44:47], v[76:79], v[108:111], v[44:47]
    v_mfma_f32_16x16x32_bf16 v[60:63], v[116:119], v[108:111], v[60:63]
    s_waitcnt lgkmcnt(0)
    s_add_u32 s52, s52, 1
    s_and_b32 s53, s52, 0xff
    s_mul_i32 s53, s53, 0x01010101
    s_mov_b32 s72, 0xffff0000
    s_mov_b32 s73, 0
    s_mov_b32 s74, 0
    s_mov_b32 s75, 0xffff
    s_mov_b32 s76, 0
    s_mov_b32 s77, 0xffff0000
    v_cndmask_b32 v10, v32, v36, s[72:73]
    v_cndmask_b32 v11, v33, v37, s[72:73]
    v_cndmask_b32 v12, v48, v52, s[72:73]
    v_cndmask_b32 v10, v10, v40, s[74:75]
    v_cndmask_b32 v11, v11, v41, s[74:75]
    v_cndmask_b32 v12, v12, v56, s[74:75]
    v_cndmask_b32 v10, v10, v44, s[76:77]
    v_cndmask_b32 v11, v11, v45, s[76:77]
    v_cndmask_b32 v12, v12, v60, s[76:77]
    v_fma_f32 v10, -v112, v12, v10
    v_fma_f32 v11, -v114, v12, v11
    v_mul_f32 v10, v113, v10
    v_mul_f32 v11, v115, v11
    v_mov_b32 v13, 0xffffff00
    s_and_b32 s43, s52, 0xff
    v_and_or_b32 v10, v10, v13, s43
    v_and_or_b32 v11, v11, v13, s43
    v_lshlrev_b32 v12, 2, v0
    s_lshl_b32 s42, s2, 9
    s_add_u32 s42, s42, 917504
    buffer_store_dword v10, v12, s[12:15], s42 offen sc1
    buffer_store_dword v11, v12, s[12:15], s42 offen offset:256 sc1
    v_lshrrev_b32 v12, 3, v0
    v_lshlrev_b32 v12, 11, v12
    v_and_b32 v13, 7, v0
    v_lshl_add_u32 v12, v13, 5, v12
    s_lshl_b32 s66, s61, 14
    s_lshl_b32 s67, s62, 8
    s_add_u32 s66, s66, s67
    s_add_u32 s68, s66, 917504
    s_mov_b32 s72, 0x0c0c0400
    s_mov_b32 s73, 0x04000c0c
    s_add_u32 s42, s65, 65536
    buffer_load_dwordx4 v[160:163], v1, s[4:7], s42 offen offset:0 nt
    buffer_load_dwordx4 v[164:167], v1, s[4:7], s42 offen offset:128 nt
    buffer_load_dwordx4 v[168:171], v122, s[4:7], s42 offen offset:0 nt
    buffer_load_dwordx4 v[172:175], v122, s[4:7], s42 offen offset:128 nt
    buffer_load_dwordx4 v[176:179], v2, s[4:7], s42 offen offset:0 nt
    buffer_load_dwordx4 v[180:183], v2, s[4:7], s42 offen offset:128 nt
    buffer_load_dwordx4 v[184:187], v123, s[4:7], s42 offen offset:0 nt
    buffer_load_dwordx4 v[188:191], v123, s[4:7], s42 offen offset:128 nt
Lpollq:
    buffer_load_dwordx4 v[64:67], v12, s[12:15], s68 offen offset:0 sc1
    buffer_load_dwordx4 v[68:71], v12, s[12:15], s68 offen offset:16 sc1
    buffer_load_dwordx4 v[72:75], v12, s[12:15], s68 offen offset:512 sc1
    buffer_load_dwordx4 v[76:79], v12, s[12:15], s68 offen offset:528 sc1
    buffer_load_dwordx4 v[80:83], v12, s[12:15], s68 offen offset:1024 sc1
    buffer_load_dwordx4 v[84:87], v12, s[12:15], s68 offen offset:1040 sc1
    buffer_load_dwordx4 v[88:91], v12, s[12:15], s68 offen offset:1536 sc1
    buffer_load_dwordx4 v[92:95], v12, s[12:15], s68 offen offset:1552 sc1
    s_waitcnt vmcnt(0)
    v_perm_b32 v8, v65, v64, s72
    v_perm_b32 v9, v67, v66, s73
    v_or_b32 v10, v8, v9
    v_xor_b32 v10, s53, v10
    v_perm_b32 v8, v69, v68, s72
    v_perm_b32 v9, v71, v70, s73
    v_or_b32 v8, v8, v9
    v_xor_b32 v8, s53, v8
    v_or_b32 v10, v10, v8
    v_perm_b32 v8, v73, v72, s72
    v_perm_b32 v9, v75, v74, s73
    v_or_b32 v8, v8, v9
    v_xor_b32 v8, s53, v8
    v_or_b32 v10, v10, v8
    v_perm_b32 v8, v77, v76, s72
    v_perm_b32 v9, v79, v78, s73
    v_or_b32 v8, v8, v9
    v_xor_b32 v8, s53, v8
    v_or_b32 v10, v10, v8
    v_perm_b32 v8, v81, v80, s72
    v_perm_b32 v9, v83, v82, s73
    v_or_b32 v8, v8, v9
    v_xor_b32 v8, s53, v8
    v_or_b32 v10, v10, v8
    v_perm_b32 v8, v85, v84, s72
    v_perm_b32 v9, v87, v86, s73
    v_or_b32 v8, v8, v9
    v_xor_b32 v8, s53, v8
    v_or_b32 v10, v10, v8
    v_perm_b32 v8, v89, v88, s72
    v_perm_b32 v9, v91, v90, s73
    v_or_b32 v8, v8, v9
    v_xor_b32 v8, s53, v8
    v_or_b32 v10, v10, v8
    v_perm_b32 v8, v93, v92, s72
    v_perm_b32 v9, v95, v94, s73
    v_or_b32 v8, v8, v9
    v_xor_b32 v8, s53, v8
    v_or_b32 v10, v10, v8
    v_cmp_ne_u32 vcc, 0, v10
    s_cbranch_vccz Lok_1
    s_add_u32 s70, s70, 1
    s_cmp_lt_u32 s70, 131072
    s_cbranch_scc1 Lpollq
Lok_1:
    v_mov_b32 v13, 0xffffff00
    v_and_b32 v64, v64, v13
    v_and_b32 v65, v65, v13
    v_and_b32 v66, v66, v13
    v_and_b32 v67, v67, v13
    v_and_b32 v68, v68, v13
    v_and_b32 v69, v69, v13
    v_and_b32 v70, v70, v13
    v_and_b32 v71, v71, v13
    v_and_b32 v72, v72, v13
    v_and_b32 v73, v73, v13
    v_and_b32 v74, v74, v13
    v_and_b32 v75, v75, v13
    v_and_b32 v76, v76, v13
    v_and_b32 v77, v77, v13
    v_and_b32 v78, v78, v13
    v_and_b32 v79, v79, v13
    v_and_b32 v80, v80, v13
    v_and_b32 v81, v81, v13
    v_and_b32 v82, v82, v13
    v_and_b32 v83, v83, v13
    v_and_b32 v84, v84, v13
    v_and_b32 v85, v85, v13
    v_and_b32 v86, v86, v13
    v_and_b32 v87, v87, v13
    v_and_b32 v88, v88, v13
    v_and_b32 v89, v89, v13
    v_and_b32 v90, v90, v13
    v_and_b32 v91, v91, v13
    v_and_b32 v92, v92, v13
    v_and_b32 v93, v93, v13
    v_and_b32 v94, v94, v13
    v_and_b32 v95, v95, v13
    v_add_f32 v64, v64, v72
    v_add_f32 v80, v80, v88
    v_add_f32 v65, v65, v73
    v_add_f32 v81, v81, v89
    v_add_f32 v66, v66, v74
    v_add_f32 v82, v82, v90
    v_add_f32 v67, v67, v75
    v_add_f32 v83, v83, v91
    v_add_f32 v68, v68, v76
    v_add_f32 v84, v84, v92
    v_add_f32 v69, v69, v77
    v_add_f32 v85, v85, v93
    v_add_f32 v70, v70, v78
    v_add_f32 v86, v86, v94
    v_add_f32 v71, v71, v79
    v_add_f32 v87, v87, v95
    v_add_f32 v64, v64, v80
    v_add_f32 v65, v65, v81
    v_add_f32 v66, v66, v82
    v_add_f32 v67, v67, v83
    v_add_f32 v68, v68, v84
    v_add_f32 v69, v69, v85
    v_add_f32 v70, v70, v86
    v_add_f32 v71, v71, v87
    v_cvt_pk_bf16_f32 v8, v64, v65
    v_cvt_pk_bf16_f32 v9, v66, v67
    v_cvt_pk_bf16_f32 v10, v68, v69
    v_cvt_pk_bf16_f32 v11, v70, v71
    v_add_u32 v5, 19200, v3
    ds_write_b128 v5, v[8:11]
    s_waitcnt lgkmcnt(0)
    s_barrier
    s_add_u32 s42, s65, 131072
    buffer_load_dwordx4 v[192:195], v1, s[4:7], s42 offen offset:0 nt
    buffer_load_dwordx4 v[196:199], v1, s[4:7], s42 offen offset:128 nt
    buffer_load_dwordx4 v[200:203], v122, s[4:7], s42 offen offset:0 nt
    buffer_load_dwordx4 v[204:207], v122, s[4:7], s42 offen offset:128 nt
    buffer_load_dwordx4 v[208:211], v2, s[4:7], s42 offen offset:0 nt
    buffer_load_dwordx4 v[212:215], v2, s[4:7], s42 offen offset:128 nt
    buffer_load_dwordx4 v[216:219], v123, s[4:7], s42 offen offset:0 nt
    buffer_load_dwordx4 v[220:223], v123, s[4:7], s42 offen offset:128 nt
    s_add_u32 s42, s65, 196608
    buffer_load_dwordx4 v[224:227], v1, s[4:7], s42 offen offset:0 nt
    buffer_load_dwordx4 v[228:231], v1, s[4:7], s42 offen offset:128 nt
    buffer_load_dwordx4 v[232:235], v122, s[4:7], s42 offen offset:0 nt
    buffer_load_dwordx4 v[236:239], v122, s[4:7], s42 offen offset:128 nt
    buffer_load_dwordx4 v[240:243], v2, s[4:7], s42 offen offset:0 nt
    buffer_load_dwordx4 v[244:247], v2, s[4:7], s42 offen offset:128 nt
    buffer_load_dwordx4 v[248:251], v123, s[4:7], s42 offen offset:0 nt
    buffer_load_dwordx4 v[252:255], v123, s[4:7], s42 offen offset:128 nt
    v_mov_b32 v108, -1
    v_mov_b32 v109, -1
    v_mov_b32 v110, -1
    v_mov_b32 v111, -1
    v_lshrrev_b32 v6, 4, v0
    v_lshlrev_b32 v8, 12, v6
    v_and_b32 v7, 15, v0
    v_lshl_add_u32 v8, v7, 4, v8
    s_lshl_b32 s42, s59, 15
    s_lshl_b32 s43, s60, 8
    s_add_u32 s42, s42, s43
    s_add_u32 s42, s42, 393216
    s_add_u32 s43, s42, 0x4000
    buffer_store_dwordx4 v[108:111], v8, s[12:15], s42 offen sc1
    buffer_store_dwordx4 v[108:111], v8, s[12:15], s43 offen sc1
    s_lshl_b32 s42, s2, 5
    s_add_u32 s42, s42, 53248
    s_mov_b64 exec, 3
    buffer_store_dwordx4 v[108:111], v3, s[12:15], s42 offen sc1
    s_mov_b64 exec, -1
    s_cmp_lt_u32 s2, 64
    s_cbranch_scc0 LclrF
    v_lshlrev_b32 v8, 11, v6
    v_lshl_add_u32 v8, v7, 4, v8
    s_lshr_b32 s42, s2, 3
    s_lshl_b32 s42, s42, 12
    s_and_b32 s43, s2, 7
    s_lshl_b32 s43, s43, 8
    s_add_u32 s42, s42, s43
    s_add_u32 s42, s42, 1048576
    s_mov_b32 exec_lo, -1
    s_mov_b32 exec_hi, 0
    buffer_store_dwordx4 v[108:111], v8, s[12:15], s42 offen sc1
    s_mov_b64 exec, -1
    s_branch Lclrdone
LclrF:
    s_cmp_lt_u32 s2, 120
    s_cbranch_scc0 Lclrdone
    v_lshrrev_b32 v6, 3, v0
    v_and_b32 v7, 7, v0
    v_lshlrev_b32 v8, 13, v6
    v_lshl_add_u32 v8, v7, 4, v8
    s_sub_u32 s42, s2, 64
    s_lshl_b32 s42, s42, 7
    s_add_u32 s42, s42, 131072
    buffer_store_dwordx4 v[108:111], v8, s[12:15], s42 offen sc1
    s_add_u32 s42, s42, 0x10000
    buffer_store_dwordx4 v[108:111], v8, s[12:15], s42 offen sc1
    s_add_u32 s42, s42, 0x10000
    buffer_store_dwordx4 v[108:111], v8, s[12:15], s42 offen sc1
    s_add_u32 s42, s42, 0x10000
    buffer_store_dwordx4 v[108:111], v8, s[12:15], s42 offen sc1
Lclrdone:
Lqread:
    v_and_b32 v5, 3, v0
    v_lshlrev_b32 v5, 8, v5
    v_lshrrev_b32 v6, 4, v0
    v_lshl_add_u32 v5, v6, 4, v5
    v_add_u32 v5, 19200, v5
    v_bfe_u32 v6, v0, 2, 1
    v_lshl_add_u32 v5, v6, 6, v5
    ds_read_b128 v[16:19], v5 offset:0
    ds_read_b128 v[20:23], v5 offset:128
    s_waitcnt lgkmcnt(0)
    s_waitcnt vmcnt(24)
    v_mfma_f32_16x16x32_bf16 v[96:99], v[128:131], v[16:19], 0
    v_mfma_f32_16x16x32_bf16 v[100:103], v[136:139], v[16:19], 0
    v_mfma_f32_16x16x32_bf16 v[104:107], v[144:147], v[16:19], 0
    v_mfma_f32_16x16x32_bf16 v[108:111], v[152:155], v[16:19], 0
    v_mfma_f32_16x16x32_bf16 v[96:99], v[132:135], v[20:23], v[96:99]
    v_mfma_f32_16x16x32_bf16 v[100:103], v[140:143], v[20:23], v[100:103]
    v_mfma_f32_16x16x32_bf16 v[104:107], v[148:151], v[20:23], v[104:107]
    v_mfma_f32_16x16x32_bf16 v[108:111], v[156:159], v[20:23], v[108:111]
    s_nop 5
    v_permlane32_swap_b32 v96, v100
    v_permlane32_swap_b32 v97, v101
    v_permlane32_swap_b32 v98, v102
    v_permlane32_swap_b32 v99, v103
    v_permlane32_swap_b32 v104, v108
    v_permlane32_swap_b32 v105, v109
    v_permlane32_swap_b32 v106, v110
    v_permlane32_swap_b32 v107, v111
    s_nop 0
    v_add_f32_dpp v32, v100, v96 row_ror:12 row_mask:0x3 bank_mask:0xf
    v_add_f32_dpp v32, v96, v100 row_ror:12 row_mask:0xc bank_mask:0xf
    v_add_f32_dpp v33, v101, v97 row_ror:12 row_mask:0x3 bank_mask:0xf
    v_add_f32_dpp v33, v97, v101 row_ror:12 row_mask:0xc bank_mask:0xf
    v_add_f32_dpp v34, v102, v98 row_ror:12 row_mask:0x3 bank_mask:0xf
    v_add_f32_dpp v34, v98, v102 row_ror:12 row_mask:0xc bank_mask:0xf
    v_add_f32_dpp v35, v103, v99 row_ror:12 row_mask:0x3 bank_mask:0xf
    v_add_f32_dpp v35, v99, v103 row_ror:12 row_mask:0xc bank_mask:0xf
    v_add_f32_dpp v36, v108, v104 row_ror:12 row_mask:0x3 bank_mask:0xf
    v_add_f32_dpp v36, v104, v108 row_ror:12 row_mask:0xc bank_mask:0xf
    v_add_f32_dpp v37, v109, v105 row_ror:12 row_mask:0x3 bank_mask:0xf
    v_add_f32_dpp v37, v105, v109 row_ror:12 row_mask:0xc bank_mask:0xf
    v_add_f32_dpp v38, v110, v106 row_ror:12 row_mask:0x3 bank_mask:0xf
    v_add_f32_dpp v38, v106, v110 row_ror:12 row_mask:0xc bank_mask:0xf
    v_add_f32_dpp v39, v111, v107 row_ror:12 row_mask:0x3 bank_mask:0xf
    v_add_f32_dpp v39, v107, v111 row_ror:12 row_mask:0xc bank_mask:0xf
    s_barrier
    s_waitcnt vmcnt(16)
    v_mfma_f32_16x16x32_bf16 v[96:99], v[160:163], v[16:19], 0
    v_mfma_f32_16x16x32_bf16 v[100:103], v[168:171], v[16:19], 0
    v_mfma_f32_16x16x32_bf16 v[104:107], v[176:179], v[16:19], 0
    v_mfma_f32_16x16x32_bf16 v[108:111], v[184:187], v[16:19], 0
    v_mfma_f32_16x16x32_bf16 v[96:99], v[164:167], v[20:23], v[96:99]
    v_mfma_f32_16x16x32_bf16 v[100:103], v[172:175], v[20:23], v[100:103]
    v_mfma_f32_16x16x32_bf16 v[104:107], v[180:183], v[20:23], v[104:107]
    v_mfma_f32_16x16x32_bf16 v[108:111], v[188:191], v[20:23], v[108:111]
    s_nop 5
    v_permlane32_swap_b32 v96, v100
    v_permlane32_swap_b32 v97, v101
    v_permlane32_swap_b32 v98, v102
    v_permlane32_swap_b32 v99, v103
    v_permlane32_swap_b32 v104, v108
    v_permlane32_swap_b32 v105, v109
    v_permlane32_swap_b32 v106, v110
    v_permlane32_swap_b32 v107, v111
    s_nop 0
    v_add_f32_dpp v40, v100, v96 row_ror:12 row_mask:0x3 bank_mask:0xf
    v_add_f32_dpp v40, v96, v100 row_ror:12 row_mask:0xc bank_mask:0xf
    v_add_f32_dpp v41, v101, v97 row_ror:12 row_mask:0x3 bank_mask:0xf
    v_add_f32_dpp v41, v97, v101 row_ror:12 row_mask:0xc bank_mask:0xf
    v_add_f32_dpp v42, v102, v98 row_ror:12 row_mask:0x3 bank_mask:0xf
    v_add_f32_dpp v42, v98, v102 row_ror:12 row_mask:0xc bank_mask:0xf
    v_add_f32_dpp v43, v103, v99 row_ror:12 row_mask:0x3 bank_mask:0xf
    v_add_f32_dpp v43, v99, v103 row_ror:12 row_mask:0xc bank_mask:0xf
    v_add_f32_dpp v44, v108, v104 row_ror:12 row_mask:0x3 bank_mask:0xf
    v_add_f32_dpp v44, v104, v108 row_ror:12 row_mask:0xc bank_mask:0xf
    v_add_f32_dpp v45, v109, v105 row_ror:12 row_mask:0x3 bank_mask:0xf
    v_add_f32_dpp v45, v105, v109 row_ror:12 row_mask:0xc bank_mask:0xf
    v_add_f32_dpp v46, v110, v106 row_ror:12 row_mask:0x3 bank_mask:0xf
    v_add_f32_dpp v46, v106, v110 row_ror:12 row_mask:0xc bank_mask:0xf
    v_add_f32_dpp v47, v111, v107 row_ror:12 row_mask:0x3 bank_mask:0xf
    v_add_f32_dpp v47, v107, v111 row_ror:12 row_mask:0xc bank_mask:0xf
    s_barrier
    s_waitcnt vmcnt(8)
    v_mfma_f32_16x16x32_bf16 v[96:99], v[192:195], v[16:19], 0
    v_mfma_f32_16x16x32_bf16 v[100:103], v[200:203], v[16:19], 0
    v_mfma_f32_16x16x32_bf16 v[104:107], v[208:211], v[16:19], 0
    v_mfma_f32_16x16x32_bf16 v[108:111], v[216:219], v[16:19], 0
    v_mfma_f32_16x16x32_bf16 v[96:99], v[196:199], v[20:23], v[96:99]
    v_mfma_f32_16x16x32_bf16 v[100:103], v[204:207], v[20:23], v[100:103]
    v_mfma_f32_16x16x32_bf16 v[104:107], v[212:215], v[20:23], v[104:107]
    v_mfma_f32_16x16x32_bf16 v[108:111], v[220:223], v[20:23], v[108:111]
    s_nop 5
    v_permlane32_swap_b32 v96, v100
    v_permlane32_swap_b32 v97, v101
    v_permlane32_swap_b32 v98, v102
    v_permlane32_swap_b32 v99, v103
    v_permlane32_swap_b32 v104, v108
    v_permlane32_swap_b32 v105, v109
    v_permlane32_swap_b32 v106, v110
    v_permlane32_swap_b32 v107, v111
    s_nop 0
    v_add_f32_dpp v48, v100, v96 row_ror:12 row_mask:0x3 bank_mask:0xf
    v_add_f32_dpp v48, v96, v100 row_ror:12 row_mask:0xc bank_mask:0xf
    v_add_f32_dpp v49, v101, v97 row_ror:12 row_mask:0x3 bank_mask:0xf
    v_add_f32_dpp v49, v97, v101 row_ror:12 row_mask:0xc bank_mask:0xf
    v_add_f32_dpp v50, v102, v98 row_ror:12 row_mask:0x3 bank_mask:0xf
    v_add_f32_dpp v50, v98, v102 row_ror:12 row_mask:0xc bank_mask:0xf
    v_add_f32_dpp v51, v103, v99 row_ror:12 row_mask:0x3 bank_mask:0xf
    v_add_f32_dpp v51, v99, v103 row_ror:12 row_mask:0xc bank_mask:0xf
    v_add_f32_dpp v52, v108, v104 row_ror:12 row_mask:0x3 bank_mask:0xf
    v_add_f32_dpp v52, v104, v108 row_ror:12 row_mask:0xc bank_mask:0xf
    v_add_f32_dpp v53, v109, v105 row_ror:12 row_mask:0x3 bank_mask:0xf
    v_add_f32_dpp v53, v105, v109 row_ror:12 row_mask:0xc bank_mask:0xf
    v_add_f32_dpp v54, v110, v106 row_ror:12 row_mask:0x3 bank_mask:0xf
    v_add_f32_dpp v54, v106, v110 row_ror:12 row_mask:0xc bank_mask:0xf
    v_add_f32_dpp v55, v111, v107 row_ror:12 row_mask:0x3 bank_mask:0xf
    v_add_f32_dpp v55, v107, v111 row_ror:12 row_mask:0xc bank_mask:0xf
    s_barrier
    s_waitcnt vmcnt(0)
    v_mfma_f32_16x16x32_bf16 v[96:99], v[224:227], v[16:19], 0
    v_mfma_f32_16x16x32_bf16 v[100:103], v[232:235], v[16:19], 0
    v_mfma_f32_16x16x32_bf16 v[104:107], v[240:243], v[16:19], 0
    v_mfma_f32_16x16x32_bf16 v[108:111], v[248:251], v[16:19], 0
    v_mfma_f32_16x16x32_bf16 v[96:99], v[228:231], v[20:23], v[96:99]
    v_mfma_f32_16x16x32_bf16 v[100:103], v[236:239], v[20:23], v[100:103]
    v_mfma_f32_16x16x32_bf16 v[104:107], v[244:247], v[20:23], v[104:107]
    v_mfma_f32_16x16x32_bf16 v[108:111], v[252:255], v[20:23], v[108:111]
    s_add_u32 s42, s65, 262144
    buffer_load_dwordx4 v[128:131], v1, s[4:7], s42 offen offset:0 nt
    buffer_load_dwordx4 v[132:135], v1, s[4:7], s42 offen offset:128 nt
    buffer_load_dwordx4 v[136:139], v122, s[4:7], s42 offen offset:0 nt
    buffer_load_dwordx4 v[140:143], v122, s[4:7], s42 offen offset:128 nt
    buffer_load_dwordx4 v[144:147], v2, s[4:7], s42 offen offset:0 nt
    buffer_load_dwordx4 v[148:151], v2, s[4:7], s42 offen offset:128 nt
    buffer_load_dwordx4 v[152:155], v123, s[4:7], s42 offen offset:0 nt
    buffer_load_dwordx4 v[156:159], v123, s[4:7], s42 offen offset:128 nt
    v_permlane32_swap_b32 v96, v100
    v_permlane32_swap_b32 v97, v101
    v_permlane32_swap_b32 v98, v102
    v_permlane32_swap_b32 v99, v103
    v_permlane32_swap_b32 v104, v108
    v_permlane32_swap_b32 v105, v109
    v_permlane32_swap_b32 v106, v110
    v_permlane32_swap_b32 v107, v111
    s_nop 0
    v_add_f32_dpp v56, v100, v96 row_ror:12 row_mask:0x3 bank_mask:0xf
    v_add_f32_dpp v56, v96, v100 row_ror:12 row_mask:0xc bank_mask:0xf
    v_add_f32_dpp v57, v101, v97 row_ror:12 row_mask:0x3 bank_mask:0xf
    v_add_f32_dpp v57, v97, v101 row_ror:12 row_mask:0xc bank_mask:0xf
    v_add_f32_dpp v58, v102, v98 row_ror:12 row_mask:0x3 bank_mask:0xf
    v_add_f32_dpp v58, v98, v102 row_ror:12 row_mask:0xc bank_mask:0xf
    v_add_f32_dpp v59, v103, v99 row_ror:12 row_mask:0x3 bank_mask:0xf
    v_add_f32_dpp v59, v99, v103 row_ror:12 row_mask:0xc bank_mask:0xf
    v_add_f32_dpp v60, v108, v104 row_ror:12 row_mask:0x3 bank_mask:0xf
    v_add_f32_dpp v60, v104, v108 row_ror:12 row_mask:0xc bank_mask:0xf
    v_add_f32_dpp v61, v109, v105 row_ror:12 row_mask:0x3 bank_mask:0xf
    v_add_f32_dpp v61, v105, v109 row_ror:12 row_mask:0xc bank_mask:0xf
    v_add_f32_dpp v62, v110, v106 row_ror:12 row_mask:0x3 bank_mask:0xf
    v_add_f32_dpp v62, v106, v110 row_ror:12 row_mask:0xc bank_mask:0xf
    v_add_f32_dpp v63, v111, v107 row_ror:12 row_mask:0x3 bank_mask:0xf
    v_add_f32_dpp v63, v107, v111 row_ror:12 row_mask:0xc bank_mask:0xf
    s_barrier
    s_waitcnt vmcnt(0)
    v_mfma_f32_16x16x32_bf16 v[96:99], v[128:131], v[16:19], 0
    v_mfma_f32_16x16x32_bf16 v[100:103], v[136:139], v[16:19], 0
    v_mfma_f32_16x16x32_bf16 v[104:107], v[144:147], v[16:19], 0
    v_mfma_f32_16x16x32_bf16 v[108:111], v[152:155], v[16:19], 0
    v_mfma_f32_16x16x32_bf16 v[96:99], v[132:135], v[20:23], v[96:99]
    v_mfma_f32_16x16x32_bf16 v[100:103], v[140:143], v[20:23], v[100:103]
    v_mfma_f32_16x16x32_bf16 v[104:107], v[148:151], v[20:23], v[104:107]
    v_mfma_f32_16x16x32_bf16 v[108:111], v[156:159], v[20:23], v[108:111]
    s_add_u32 s42, s65, 327680
    buffer_load_dwordx4 v[160:163], v1, s[4:7], s42 offen offset:0 nt
    buffer_load_dwordx4 v[164:167], v1, s[4:7], s42 offen offset:128 nt
    buffer_load_dwordx4 v[168:171], v122, s[4:7], s42 offen offset:0 nt
    buffer_load_dwordx4 v[172:175], v122, s[4:7], s42 offen offset:128 nt
    buffer_load_dwordx4 v[176:179], v2, s[4:7], s42 offen offset:0 nt
    buffer_load_dwordx4 v[180:183], v2, s[4:7], s42 offen offset:128 nt
    buffer_load_dwordx4 v[184:187], v123, s[4:7], s42 offen offset:0 nt
    buffer_load_dwordx4 v[188:191], v123, s[4:7], s42 offen offset:128 nt
    v_permlane32_swap_b32 v96, v100
    v_permlane32_swap_b32 v97, v101
    v_permlane32_swap_b32 v98, v102
    v_permlane32_swap_b32 v99, v103
    v_permlane32_swap_b32 v104, v108
    v_permlane32_swap_b32 v105, v109
    v_permlane32_swap_b32 v106, v110
    v_permlane32_swap_b32 v107, v111
    s_nop 0
    v_add_f32_dpp v64, v100, v96 row_ror:12 row_mask:0x3 bank_mask:0xf
    v_add_f32_dpp v64, v96, v100 row_ror:12 row_mask:0xc bank_mask:0xf
    v_add_f32_dpp v65, v101, v97 row_ror:12 row_mask:0x3 bank_mask:0xf
    v_add_f32_dpp v65, v97, v101 row_ror:12 row_mask:0xc bank_mask:0xf
    v_add_f32_dpp v66, v102, v98 row_ror:12 row_mask:0x3 bank_mask:0xf
    v_add_f32_dpp v66, v98, v102 row_ror:12 row_mask:0xc bank_mask:0xf
    v_add_f32_dpp v67, v103, v99 row_ror:12 row_mask:0x3 bank_mask:0xf
    v_add_f32_dpp v67, v99, v103 row_ror:12 row_mask:0xc bank_mask:0xf
    v_add_f32_dpp v68, v108, v104 row_ror:12 row_mask:0x3 bank_mask:0xf
    v_add_f32_dpp v68, v104, v108 row_ror:12 row_mask:0xc bank_mask:0xf
    v_add_f32_dpp v69, v109, v105 row_ror:12 row_mask:0x3 bank_mask:0xf
    v_add_f32_dpp v69, v105, v109 row_ror:12 row_mask:0xc bank_mask:0xf
    v_add_f32_dpp v70, v110, v106 row_ror:12 row_mask:0x3 bank_mask:0xf
    v_add_f32_dpp v70, v106, v110 row_ror:12 row_mask:0xc bank_mask:0xf
    v_add_f32_dpp v71, v111, v107 row_ror:12 row_mask:0x3 bank_mask:0xf
    v_add_f32_dpp v71, v107, v111 row_ror:12 row_mask:0xc bank_mask:0xf
    s_barrier
    s_cmp_eq_u32 s3, 0
    s_cbranch_scc0 Lnw_2
    v_mov_b32 v13, s52
    s_lshl_b32 s43, s2, 2
    s_add_u32 s43, s43, 1024
    v_mov_b32 v14, 0
    s_mov_b64 exec, 1
    buffer_store_dword v13, v14, s[12:15], s43 offen sc1
    s_mov_b64 exec, -1
Lnw_2:
    s_waitcnt vmcnt(0)
    v_mfma_f32_16x16x32_bf16 v[96:99], v[160:163], v[16:19], 0
    v_mfma_f32_16x16x32_bf16 v[100:103], v[168:171], v[16:19], 0
    v_mfma_f32_16x16x32_bf16 v[104:107], v[176:179], v[16:19], 0
    v_mfma_f32_16x16x32_bf16 v[108:111], v[184:187], v[16:19], 0
    v_mfma_f32_16x16x32_bf16 v[96:99], v[164:167], v[20:23], v[96:99]
    v_mfma_f32_16x16x32_bf16 v[100:103], v[172:175], v[20:23], v[100:103]
    v_mfma_f32_16x16x32_bf16 v[104:107], v[180:183], v[20:23], v[104:107]
    v_mfma_f32_16x16x32_bf16 v[108:111], v[188:191], v[20:23], v[108:111]
    s_add_u32 s42, s65, 393216
    buffer_load_dwordx4 v[192:195], v1, s[4:7], s42 offen offset:0 nt
    buffer_load_dwordx4 v[196:199], v1, s[4:7], s42 offen offset:128 nt
    buffer_load_dwordx4 v[200:203], v122, s[4:7], s42 offen offset:0 nt
    buffer_load_dwordx4 v[204:207], v122, s[4:7], s42 offen offset:128 nt
    buffer_load_dwordx4 v[208:211], v2, s[4:7], s42 offen offset:0 nt
    buffer_load_dwordx4 v[212:215], v2, s[4:7], s42 offen offset:128 nt
    buffer_load_dwordx4 v[216:219], v123, s[4:7], s42 offen offset:0 nt
    buffer_load_dwordx4 v[220:223], v123, s[4:7], s42 offen offset:128 nt
    v_permlane32_swap_b32 v96, v100
    v_permlane32_swap_b32 v97, v101
    v_permlane32_swap_b32 v98, v102
    v_permlane32_swap_b32 v99, v103
    v_permlane32_swap_b32 v104, v108
    v_permlane32_swap_b32 v105, v109
    v_permlane32_swap_b32 v106, v110
    v_permlane32_swap_b32 v107, v111
    s_nop 0
    v_add_f32_dpp v72, v100, v96 row_ror:12 row_mask:0x3 bank_mask:0xf
    v_add_f32_dpp v72, v96, v100 row_ror:12 row_mask:0xc bank_mask:0xf
    v_add_f32_dpp v73, v101, v97 row_ror:12 row_mask:0x3 bank_mask:0xf
    v_add_f32_dpp v73, v97, v101 row_ror:12 row_mask:0xc bank_mask:0xf
    v_add_f32_dpp v74, v102, v98 row_ror:12 row_mask:0x3 bank_mask:0xf
    v_add_f32_dpp v74, v98, v102 row_ror:12 row_mask:0xc bank_mask:0xf
    v_add_f32_dpp v75, v103, v99 row_ror:12 row_mask:0x3 bank_mask:0xf
    v_add_f32_dpp v75, v99, v103 row_ror:12 row_mask:0xc bank_mask:0xf
    v_add_f32_dpp v76, v108, v104 row_ror:12 row_mask:0x3 bank_mask:0xf
    v_add_f32_dpp v76, v104, v108 row_ror:12 row_mask:0xc bank_mask:0xf
    v_add_f32_dpp v77, v109, v105 row_ror:12 row_mask:0x3 bank_mask:0xf
    v_add_f32_dpp v77, v105, v109 row_ror:12 row_mask:0xc bank_mask:0xf
    v_add_f32_dpp v78, v110, v106 row_ror:12 row_mask:0x3 bank_mask:0xf
    v_add_f32_dpp v78, v106, v110 row_ror:12 row_mask:0xc bank_mask:0xf
    v_add_f32_dpp v79, v111, v107 row_ror:12 row_mask:0x3 bank_mask:0xf
    v_add_f32_dpp v79, v107, v111 row_ror:12 row_mask:0xc bank_mask:0xf
    s_barrier
    s_waitcnt vmcnt(0)
    v_mfma_f32_16x16x32_bf16 v[96:99], v[192:195], v[16:19], 0
    v_mfma_f32_16x16x32_bf16 v[100:103], v[200:203], v[16:19], 0
    v_mfma_f32_16x16x32_bf16 v[104:107], v[208:211], v[16:19], 0
    v_mfma_f32_16x16x32_bf16 v[108:111], v[216:219], v[16:19], 0
    v_mfma_f32_16x16x32_bf16 v[96:99], v[196:199], v[20:23], v[96:99]
    v_mfma_f32_16x16x32_bf16 v[100:103], v[204:207], v[20:23], v[100:103]
    v_mfma_f32_16x16x32_bf16 v[104:107], v[212:215], v[20:23], v[104:107]
    v_mfma_f32_16x16x32_bf16 v[108:111], v[220:223], v[20:23], v[108:111]
    s_add_u32 s42, s65, 458752
    buffer_load_dwordx4 v[224:227], v1, s[4:7], s42 offen offset:0 nt
    buffer_load_dwordx4 v[228:231], v1, s[4:7], s42 offen offset:128 nt
    buffer_load_dwordx4 v[232:235], v122, s[4:7], s42 offen offset:0 nt
    buffer_load_dwordx4 v[236:239], v122, s[4:7], s42 offen offset:128 nt
    buffer_load_dwordx4 v[240:243], v2, s[4:7], s42 offen offset:0 nt
    buffer_load_dwordx4 v[244:247], v2, s[4:7], s42 offen offset:128 nt
    buffer_load_dwordx4 v[248:251], v123, s[4:7], s42 offen offset:0 nt
    buffer_load_dwordx4 v[252:255], v123, s[4:7], s42 offen offset:128 nt
    s_add_u32 s42, s65, 0
    buffer_load_dwordx4 v[128:131], v3, s[8:11], s42 offen offset:0 nt
    buffer_load_dwordx4 v[132:135], v3, s[8:11], s42 offen offset:1024 nt
    buffer_load_dwordx4 v[136:139], v3, s[8:11], s42 offen offset:2048 nt
    buffer_load_dwordx4 v[140:143], v3, s[8:11], s42 offen offset:3072 nt
    buffer_load_dwordx4 v[144:147], v4, s[8:11], s42 offen offset:0 nt
    buffer_load_dwordx4 v[148:151], v4, s[8:11], s42 offen offset:1024 nt
    buffer_load_dwordx4 v[152:155], v4, s[8:11], s42 offen offset:2048 nt
    buffer_load_dwordx4 v[156:159], v4, s[8:11], s42 offen offset:3072 nt
    v_permlane32_swap_b32 v96, v100
    v_permlane32_swap_b32 v97, v101
    v_permlane32_swap_b32 v98, v102
    v_permlane32_swap_b32 v99, v103
    v_permlane32_swap_b32 v104, v108
    v_permlane32_swap_b32 v105, v109
    v_permlane32_swap_b32 v106, v110
    v_permlane32_swap_b32 v107, v111
    s_nop 0
    v_add_f32_dpp v80, v100, v96 row_ror:12 row_mask:0x3 bank_mask:0xf
    v_add_f32_dpp v80, v96, v100 row_ror:12 row_mask:0xc bank_mask:0xf
    v_add_f32_dpp v81, v101, v97 row_ror:12 row_mask:0x3 bank_mask:0xf
    v_add_f32_dpp v81, v97, v101 row_ror:12 row_mask:0xc bank_mask:0xf
    v_add_f32_dpp v82, v102, v98 row_ror:12 row_mask:0x3 bank_mask:0xf
    v_add_f32_dpp v82, v98, v102 row_ror:12 row_mask:0xc bank_mask:0xf
    v_add_f32_dpp v83, v103, v99 row_ror:12 row_mask:0x3 bank_mask:0xf
    v_add_f32_dpp v83, v99, v103 row_ror:12 row_mask:0xc bank_mask:0xf
    v_add_f32_dpp v84, v108, v104 row_ror:12 row_mask:0x3 bank_mask:0xf
    v_add_f32_dpp v84, v104, v108 row_ror:12 row_mask:0xc bank_mask:0xf
    v_add_f32_dpp v85, v109, v105 row_ror:12 row_mask:0x3 bank_mask:0xf
    v_add_f32_dpp v85, v105, v109 row_ror:12 row_mask:0xc bank_mask:0xf
    v_add_f32_dpp v86, v110, v106 row_ror:12 row_mask:0x3 bank_mask:0xf
    v_add_f32_dpp v86, v106, v110 row_ror:12 row_mask:0xc bank_mask:0xf
    v_add_f32_dpp v87, v111, v107 row_ror:12 row_mask:0x3 bank_mask:0xf
    v_add_f32_dpp v87, v107, v111 row_ror:12 row_mask:0xc bank_mask:0xf
    s_barrier
    s_waitcnt vmcnt(8)
    v_mfma_f32_16x16x32_bf16 v[96:99], v[224:227], v[16:19], 0
    v_mfma_f32_16x16x32_bf16 v[100:103], v[232:235], v[16:19], 0
    v_mfma_f32_16x16x32_bf16 v[104:107], v[240:243], v[16:19], 0
    v_mfma_f32_16x16x32_bf16 v[108:111], v[248:251], v[16:19], 0
    v_mfma_f32_16x16x32_bf16 v[96:99], v[228:231], v[20:23], v[96:99]
    v_mfma_f32_16x16x32_bf16 v[100:103], v[236:239], v[20:23], v[100:103]
    v_mfma_f32_16x16x32_bf16 v[104:107], v[244:247], v[20:23], v[104:107]
    v_mfma_f32_16x16x32_bf16 v[108:111], v[252:255], v[20:23], v[108:111]
    s_add_u32 s42, s65, 65536
    buffer_load_dwordx4 v[160:163], v3, s[8:11], s42 offen offset:0 nt
    buffer_load_dwordx4 v[164:167], v3, s[8:11], s42 offen offset:1024 nt
    buffer_load_dwordx4 v[168:171], v3, s[8:11], s42 offen offset:2048 nt
    buffer_load_dwordx4 v[172:175], v3, s[8:11], s42 offen offset:3072 nt
    buffer_load_dwordx4 v[176:179], v4, s[8:11], s42 offen offset:0 nt
    buffer_load_dwordx4 v[180:183], v4, s[8:11], s42 offen offset:1024 nt
    buffer_load_dwordx4 v[184:187], v4, s[8:11], s42 offen offset:2048 nt
    buffer_load_dwordx4 v[188:191], v4, s[8:11], s42 offen offset:3072 nt
    v_permlane32_swap_b32 v96, v100
    v_permlane32_swap_b32 v97, v101
    v_permlane32_swap_b32 v98, v102
    v_permlane32_swap_b32 v99, v103
    v_permlane32_swap_b32 v104, v108
    v_permlane32_swap_b32 v105, v109
    v_permlane32_swap_b32 v106, v110
    v_permlane32_swap_b32 v107, v111
    s_nop 0
    v_add_f32_dpp v88, v100, v96 row_ror:12 row_mask:0x3 bank_mask:0xf
    v_add_f32_dpp v88, v96, v100 row_ror:12 row_mask:0xc bank_mask:0xf
    v_add_f32_dpp v89, v101, v97 row_ror:12 row_mask:0x3 bank_mask:0xf
    v_add_f32_dpp v89, v97, v101 row_ror:12 row_mask:0xc bank_mask:0xf
    v_add_f32_dpp v90, v102, v98 row_ror:12 row_mask:0x3 bank_mask:0xf
    v_add_f32_dpp v90, v98, v102 row_ror:12 row_mask:0xc bank_mask:0xf
    v_add_f32_dpp v91, v103, v99 row_ror:12 row_mask:0x3 bank_mask:0xf
    v_add_f32_dpp v91, v99, v103 row_ror:12 row_mask:0xc bank_mask:0xf
    v_add_f32_dpp v92, v108, v104 row_ror:12 row_mask:0x3 bank_mask:0xf
    v_add_f32_dpp v92, v104, v108 row_ror:12 row_mask:0xc bank_mask:0xf
    v_add_f32_dpp v93, v109, v105 row_ror:12 row_mask:0x3 bank_mask:0xf
    v_add_f32_dpp v93, v105, v109 row_ror:12 row_mask:0xc bank_mask:0xf
    v_add_f32_dpp v94, v110, v106 row_ror:12 row_mask:0x3 bank_mask:0xf
    v_add_f32_dpp v94, v106, v110 row_ror:12 row_mask:0xc bank_mask:0xf
    v_add_f32_dpp v95, v111, v107 row_ror:12 row_mask:0x3 bank_mask:0xf
    v_add_f32_dpp v95, v107, v111 row_ror:12 row_mask:0xc bank_mask:0xf
    s_barrier
    v_max3_f32 v5, v32, v33, v34
    v_max3_f32 v5, v5, v35, v36
    v_max3_f32 v5, v5, v37, v38
    v_max3_f32 v5, v5, v39, v40
    v_max3_f32 v5, v5, v41, v42
    v_max3_f32 v5, v5, v43, v44
    v_max3_f32 v5, v5, v45, v46
    v_max_f32 v5, v5, v47
    v_max3_f32 v6, v48, v49, v50
    v_max3_f32 v6, v6, v51, v52
    v_max3_f32 v6, v6, v53, v54
    v_max3_f32 v6, v6, v55, v56
    v_max3_f32 v6, v6, v57, v58
    v_max3_f32 v6, v6, v59, v60
    v_max3_f32 v6, v6, v61, v62
    v_max_f32 v6, v6, v63
    v_max3_f32 v7, v64, v65, v66
    v_max3_f32 v7, v7, v67, v68
    v_max3_f32 v7, v7, v69, v70
    v_max3_f32 v7, v7, v71, v72
    v_max3_f32 v7, v7, v73, v74
    v_max3_f32 v7, v7, v75, v76
    v_max3_f32 v7, v7, v77, v78
    v_max_f32 v7, v7, v79
    v_max3_f32 v8, v80, v81, v82
    v_max3_f32 v8, v8, v83, v84
    v_max3_f32 v8, v8, v85, v86
    v_max3_f32 v8, v8, v87, v88
    v_max3_f32 v8, v8, v89, v90
    v_max3_f32 v8, v8, v91, v92
    v_max3_f32 v8, v8, v93, v94
    v_max_f32 v8, v8, v95
    v_max3_f32 v5, v5, v6, v7
    v_max_f32 v5, v5, v8
    v_mov_b32 v6, v5
    s_nop 1
    v_permlane16_swap_b32 v6, v5
    s_nop 0
    v_max_f32 v5, v5, v6
    v_mov_b32 v6, v5
    s_nop 1
    v_permlane32_swap_b32 v6, v5
    s_nop 0
    v_max_f32 v5, v5, v6
    v_mul_f32 v106, s56, v5
    v_fma_f32 v32, v32, s56, -v106
    v_fma_f32 v33, v33, s56, -v106
    v_fma_f32 v34, v34, s56, -v106
    v_fma_f32 v35, v35, s56, -v106
    v_fma_f32 v36, v36, s56, -v106
    v_fma_f32 v37, v37, s56, -v106
    v_fma_f32 v38, v38, s56, -v106
    v_fma_f32 v39, v39, s56, -v106
    v_fma_f32 v40, v40, s56, -v106
    v_fma_f32 v41, v41, s56, -v106
    v_fma_f32 v42, v42, s56, -v106
    v_fma_f32 v43, v43, s56, -v106
    v_fma_f32 v44, v44, s56, -v106
    v_fma_f32 v45, v45, s56, -v106
    v_fma_f32 v46, v46, s56, -v106
    v_fma_f32 v47, v47, s56, -v106
    v_fma_f32 v48, v48, s56, -v106
    v_fma_f32 v49, v49, s56, -v106
    v_fma_f32 v50, v50, s56, -v106
    v_fma_f32 v51, v51, s56, -v106
    v_fma_f32 v52, v52, s56, -v106
    v_fma_f32 v53, v53, s56, -v106
    v_fma_f32 v54, v54, s56, -v106
    v_fma_f32 v55, v55, s56, -v106
    v_fma_f32 v56, v56, s56, -v106
    v_fma_f32 v57, v57, s56, -v106
    v_fma_f32 v58, v58, s56, -v106
    v_fma_f32 v59, v59, s56, -v106
    v_fma_f32 v60, v60, s56, -v106
    v_fma_f32 v61, v61, s56, -v106
    v_fma_f32 v62, v62, s56, -v106
    v_fma_f32 v63, v63, s56, -v106
    v_fma_f32 v64, v64, s56, -v106
    v_fma_f32 v65, v65, s56, -v106
    v_fma_f32 v66, v66, s56, -v106
    v_fma_f32 v67, v67, s56, -v106
    v_fma_f32 v68, v68, s56, -v106
    v_fma_f32 v69, v69, s56, -v106
    v_fma_f32 v70, v70, s56, -v106
    v_fma_f32 v71, v71, s56, -v106
    v_fma_f32 v72, v72, s56, -v106
    v_fma_f32 v73, v73, s56, -v106
    v_fma_f32 v74, v74, s56, -v106
    v_fma_f32 v75, v75, s56, -v106
    v_fma_f32 v76, v76, s56, -v106
    v_fma_f32 v77, v77, s56, -v106
    v_fma_f32 v78, v78, s56, -v106
    v_fma_f32 v79, v79, s56, -v106
    v_fma_f32 v80, v80, s56, -v106
    v_fma_f32 v81, v81, s56, -v106
    v_fma_f32 v82, v82, s56, -v106
    v_fma_f32 v83, v83, s56, -v106
    v_fma_f32 v84, v84, s56, -v106
    v_fma_f32 v85, v85, s56, -v106
    v_fma_f32 v86, v86, s56, -v106
    v_fma_f32 v87, v87, s56, -v106
    v_fma_f32 v88, v88, s56, -v106
    v_fma_f32 v89, v89, s56, -v106
    v_fma_f32 v90, v90, s56, -v106
    v_fma_f32 v91, v91, s56, -v106
    v_fma_f32 v92, v92, s56, -v106
    v_fma_f32 v93, v93, s56, -v106
    v_fma_f32 v94, v94, s56, -v106
    v_fma_f32 v95, v95, s56, -v106
    v_exp_f32 v32, v32
    v_exp_f32 v33, v33
    v_exp_f32 v34, v34
    v_exp_f32 v35, v35
    v_exp_f32 v36, v36
    v_exp_f32 v37, v37
    v_exp_f32 v38, v38
    v_exp_f32 v39, v39
    v_exp_f32 v40, v40
    v_exp_f32 v41, v41
    v_exp_f32 v42, v42
    v_exp_f32 v43, v43
    v_exp_f32 v44, v44
    v_exp_f32 v45, v45
    v_exp_f32 v46, v46
    v_exp_f32 v47, v47
    v_exp_f32 v48, v48
    v_exp_f32 v49, v49
    v_exp_f32 v50, v50
    v_exp_f32 v51, v51
    v_exp_f32 v52, v52
    v_exp_f32 v53, v53
    v_exp_f32 v54, v54
    v_exp_f32 v55, v55
    v_exp_f32 v56, v56
    v_exp_f32 v57, v57
    v_exp_f32 v58, v58
    v_exp_f32 v59, v59
    v_exp_f32 v60, v60
    v_exp_f32 v61, v61
    v_exp_f32 v62, v62
    v_exp_f32 v63, v63
    v_exp_f32 v64, v64
    v_exp_f32 v65, v65
    v_exp_f32 v66, v66
    v_exp_f32 v67, v67
    v_exp_f32 v68, v68
    v_exp_f32 v69, v69
    v_exp_f32 v70, v70
    v_exp_f32 v71, v71
    v_exp_f32 v72, v72
    v_exp_f32 v73, v73
    v_exp_f32 v74, v74
    v_exp_f32 v75, v75
    v_exp_f32 v76, v76
    v_exp_f32 v77, v77
    v_exp_f32 v78, v78
    v_exp_f32 v79, v79
    v_exp_f32 v80, v80
    v_exp_f32 v81, v81
    v_exp_f32 v82, v82
    v_exp_f32 v83, v83
    v_exp_f32 v84, v84
    v_exp_f32 v85, v85
    v_exp_f32 v86, v86
    v_exp_f32 v87, v87
    v_exp_f32 v88, v88
    v_exp_f32 v89, v89
    v_exp_f32 v90, v90
    v_exp_f32 v91, v91
    v_exp_f32 v92, v92
    v_exp_f32 v93, v93
    v_exp_f32 v94, v94
    v_exp_f32 v95, v95
    v_add_f32 v5, v32, v33
    v_add_f32 v6, v48, v49
    v_add_f32 v7, v64, v65
    v_add_f32 v8, v80, v81
    v_add_f32 v5, v5, v34
    v_add_f32 v6, v6, v50
    v_add_f32 v7, v7, v66
    v_add_f32 v8, v8, v82
    v_add_f32 v5, v5, v35
    v_add_f32 v6, v6, v51
    v_add_f32 v7, v7, v67
    v_add_f32 v8, v8, v83
    v_add_f32 v5, v5, v36
    v_add_f32 v6, v6, v52
    v_add_f32 v7, v7, v68
    v_add_f32 v8, v8, v84
    v_add_f32 v5, v5, v37
    v_add_f32 v6, v6, v53
    v_add_f32 v7, v7, v69
    v_add_f32 v8, v8, v85
    v_add_f32 v5, v5, v38
    v_add_f32 v6, v6, v54
    v_add_f32 v7, v7, v70
    v_add_f32 v8, v8, v86
    v_add_f32 v5, v5, v39
    v_add_f32 v6, v6, v55
    v_add_f32 v7, v7, v71
    v_add_f32 v8, v8, v87
    v_add_f32 v5, v5, v40
    v_add_f32 v6, v6, v56
    v_add_f32 v7, v7, v72
    v_add_f32 v8, v8, v88
    v_add_f32 v5, v5, v41
    v_add_f32 v6, v6, v57
    v_add_f32 v7, v7, v73
    v_add_f32 v8, v8, v89
    v_add_f32 v5, v5, v42
    v_add_f32 v6, v6, v58
    v_add_f32 v7, v7, v74
    v_add_f32 v8, v8, v90
    v_add_f32 v5, v5, v43
    v_add_f32 v6, v6, v59
    v_add_f32 v7, v7, v75
    v_add_f32 v8, v8, v91
    v_add_f32 v5, v5, v44
    v_add_f32 v6, v6, v60
    v_add_f32 v7, v7, v76
    v_add_f32 v8, v8, v92
    v_add_f32 v5, v5, v45
    v_add_f32 v6, v6, v61
    v_add_f32 v7, v7, v77
    v_add_f32 v8, v8, v93
    v_add_f32 v5, v5, v46
    v_add_f32 v6, v6, v62
    v_add_f32 v7, v7, v78
    v_add_f32 v8, v8, v94
    v_add_f32 v5, v5, v47
    v_add_f32 v6, v6, v63
    v_add_f32 v7, v7, v79
    v_add_f32 v8, v8, v95
    v_add_f32 v5, v5, v6
    v_add_f32 v7, v7, v8
    v_add_f32 v107, v5, v7
    v_mov_b32 v6, v107
    s_nop 1
    v_permlane16_swap_b32 v6, v107
    s_nop 0
    v_add_f32 v107, v107, v6
    v_mov_b32 v6, v107
    s_nop 1
    v_permlane32_swap_b32 v6, v107
    s_nop 0
    v_add_f32 v107, v107, v6
    v_cvt_pk_bf16_f32 v32, v32, v33
    v_cvt_pk_bf16_f32 v33, v34, v35
    v_cvt_pk_bf16_f32 v34, v36, v37
    v_cvt_pk_bf16_f32 v35, v38, v39
    v_cvt_pk_bf16_f32 v36, v40, v41
    v_cvt_pk_bf16_f32 v37, v42, v43
    v_cvt_pk_bf16_f32 v38, v44, v45
    v_cvt_pk_bf16_f32 v39, v46, v47
    v_cvt_pk_bf16_f32 v40, v48, v49
    v_cvt_pk_bf16_f32 v41, v50, v51
    v_cvt_pk_bf16_f32 v42, v52, v53
    v_cvt_pk_bf16_f32 v43, v54, v55
    v_cvt_pk_bf16_f32 v44, v56, v57
    v_cvt_pk_bf16_f32 v45, v58, v59
    v_cvt_pk_bf16_f32 v46, v60, v61
    v_cvt_pk_bf16_f32 v47, v62, v63
    v_cvt_pk_bf16_f32 v48, v64, v65
    v_cvt_pk_bf16_f32 v49, v66, v67
    v_cvt_pk_bf16_f32 v50, v68, v69
    v_cvt_pk_bf16_f32 v51, v70, v71
    v_cvt_pk_bf16_f32 v52, v72, v73
    v_cvt_pk_bf16_f32 v53, v74, v75
    v_cvt_pk_bf16_f32 v54, v76, v77
    v_cvt_pk_bf16_f32 v55, v78, v79
    v_cvt_pk_bf16_f32 v56, v80, v81
    v_cvt_pk_bf16_f32 v57, v82, v83
    v_cvt_pk_bf16_f32 v58, v84, v85
    v_cvt_pk_bf16_f32 v59, v86, v87
    v_cvt_pk_bf16_f32 v60, v88, v89
    v_cvt_pk_bf16_f32 v61, v90, v91
    v_cvt_pk_bf16_f32 v62, v92, v93
    v_cvt_pk_bf16_f32 v63, v94, v95
    v_and_b32 v5, 3, v0
    v_lshlrev_b32 v5, 3, v5
    s_lshl_b32 s42, s3, 5
    s_add_u32 s42, s42, 23296
    v_add_u32 v5, s42, v5
    v_mov_b32 v6, 23680
    v_mov_b32 v7, 1
    s_mov_b64 exec, 0xf
    ds_write_b64 v5, v[106:107]
    s_waitcnt lgkmcnt(0)
    s_mov_b64 exec, 1
    ds_add_rtn_u32 v8, v6, v7
    s_waitcnt lgkmcnt(0)
    s_mov_b64 exec, -1
    v_readfirstlane_b32 s42, v8
    s_nop 3
    s_cmp_eq_u32 s42, 7
    s_cbranch_scc0 Lnotlast
    v_and_b32 v5, 31, v0
    v_lshlrev_b32 v5, 3, v5
    v_add_u32 v5, 23296, v5
    ds_read_b64 v[8:9], v5
    s_waitcnt lgkmcnt(0)
    v_mov_b32 v10, v8
    s_nop 1
    v_max_f32_dpp v10, v10, v10 row_ror:4 row_mask:0xf bank_mask:0xf
    s_nop 1
    v_max_f32_dpp v10, v10, v10 row_ror:8 row_mask:0xf bank_mask:0xf
    v_mov_b32 v11, v10
    s_nop 1
    v_permlane16_swap_b32 v11, v10
    s_nop 0
    v_max_f32 v10, v10, v11
    v_sub_f32 v8, v8, v10
    v_exp_f32 v8, v8
    s_nop 0
    v_mul_f32 v11, v8, v9
    s_nop 1
    v_add_f32_dpp v11, v11, v11 row_ror:4 row_mask:0xf bank_mask:0xf
    s_nop 1
    v_add_f32_dpp v11, v11, v11 row_ror:8 row_mask:0xf bank_mask:0xf
    v_mov_b32 v12, v11
    s_nop 1
    v_permlane16_swap_b32 v12, v11
    s_nop 0
    v_add_f32 v11, v11, v12
    v_and_b32 v12, 3, v0
    v_bfe_u32 v13, v0, 2, 3
    v_lshl_add_u32 v13, v12, 3, v13
    v_lshlrev_b32 v13, 2, v13
    v_add_u32 v13, 23552, v13
    v_lshlrev_b32 v12, 3, v12
    s_lshl_b32 s42, s2, 5
    s_add_u32 s42, s42, 53248
    s_mov_b32 exec_lo, -1
    s_mov_b32 exec_hi, 0
    ds_write_b32 v13, v8
    s_mov_b64 exec, 0xf
    buffer_store_dwordx2 v[10:11], v12, s[12:15], s42 offen sc1
    s_mov_b64 exec, -1
Lnotlast:
    v_and_b32 v5, 3, v0
    v_lshlrev_b32 v5, 2, v5
    v_lshrrev_b32 v6, 4, v0
    v_add_u32 v5, v5, v6
    v_lshlrev_b32 v5, 4, v5
    s_mul_i32 s42, s3, 2080
    v_add_u32 v118, s42, v5
    s_lshl_b32 s42, s3, 6
    v_add_u32 v5, s42, v0
    v_lshlrev_b32 v119, 4, v5
    v_bfe_u32 v7, v5, 2, 2
    v_lshlrev_b32 v120, 5, v7
    v_add_u32 v120, 23552, v120
    v_lshrrev_b32 v9, 6, v5
    v_lshl_add_u32 v9, v7, 1, v9
    v_lshlrev_b32 v9, 12, v9
    v_bfe_u32 v10, v5, 4, 2
    v_lshl_add_u32 v9, v10, 6, v9
    v_and_b32 v10, 3, v5
    v_lshl_add_u32 v121, v10, 4, v9
    s_lshl_b32 s42, s59, 15
    s_lshl_b32 s43, s60, 8
    s_add_u32 s42, s42, s43
    s_add_u32 s69, s42, 393216
    v_mov_b32 v117, 0
    s_waitcnt vmcnt(8)
    v_perm_b32 v96, v132, v128, s57
    v_perm_b32 v97, v140, v136, s57
    v_perm_b32 v98, v148, v144, s57
    v_perm_b32 v99, v156, v152, s57
    v_perm_b32 v100, v132, v128, s58
    v_perm_b32 v101, v140, v136, s58
    v_perm_b32 v102, v148, v144, s58
    v_perm_b32 v103, v156, v152, s58
    v_mfma_f32_16x16x32_bf16 v[64:67], v[96:99], v[32:35], 0
    v_perm_b32 v96, v133, v129, s57
    v_perm_b32 v97, v141, v137, s57
    v_perm_b32 v98, v149, v145, s57
    v_perm_b32 v99, v157, v153, s57
    v_mfma_f32_16x16x32_bf16 v[68:71], v[100:103], v[32:35], 0
    v_perm_b32 v100, v133, v129, s58
    v_perm_b32 v101, v141, v137, s58
    v_perm_b32 v102, v149, v145, s58
    v_perm_b32 v103, v157, v153, s58
    v_mfma_f32_16x16x32_bf16 v[72:75], v[96:99], v[32:35], 0
    v_perm_b32 v96, v134, v130, s57
    v_perm_b32 v97, v142, v138, s57
    v_perm_b32 v98, v150, v146, s57
    v_perm_b32 v99, v158, v154, s57
    v_mfma_f32_16x16x32_bf16 v[76:79], v[100:103], v[32:35], 0
    v_perm_b32 v100, v134, v130, s58
    v_perm_b32 v101, v142, v138, s58
    v_perm_b32 v102, v150, v146, s58
    v_perm_b32 v103, v158, v154, s58
    v_mfma_f32_16x16x32_bf16 v[80:83], v[96:99], v[32:35], 0
    v_perm_b32 v96, v135, v131, s57
    v_perm_b32 v97, v143, v139, s57
    v_perm_b32 v98, v151, v147, s57
    v_perm_b32 v99, v159, v155, s57
    v_mfma_f32_16x16x32_bf16 v[84:87], v[100:103], v[32:35], 0
    v_perm_b32 v100, v135, v131, s58
    v_perm_b32 v101, v143, v139, s58
    v_perm_b32 v102, v151, v147, s58
    v_perm_b32 v103, v159, v155, s58
    v_mfma_f32_16x16x32_bf16 v[88:91], v[96:99], v[32:35], 0
    s_nop 0
    v_mfma_f32_16x16x32_bf16 v[92:95], v[100:103], v[32:35], 0
    s_barrier
    s_cmp_eq_u32 s3, 2
    s_cbranch_scc0 Lnw_3
    buffer_load_dwordx4 v[108:111], v3, s[12:15], 0 offen offset:1024 sc1
Lnw_3:
    s_waitcnt vmcnt(0)
    v_perm_b32 v96, v164, v160, s57
    v_perm_b32 v97, v172, v168, s57
    v_perm_b32 v98, v180, v176, s57
    v_perm_b32 v99, v188, v184, s57
    v_perm_b32 v100, v164, v160, s58
    v_perm_b32 v101, v172, v168, s58
    v_perm_b32 v102, v180, v176, s58
    v_perm_b32 v103, v188, v184, s58
    v_mfma_f32_16x16x32_bf16 v[64:67], v[96:99], v[36:39], v[64:67]
    v_perm_b32 v96, v165, v161, s57
    v_perm_b32 v97, v173, v169, s57
    v_perm_b32 v98, v181, v177, s57
    v_perm_b32 v99, v189, v185, s57
    v_mfma_f32_16x16x32_bf16 v[68:71], v[100:103], v[36:39], v[68:71]
    v_perm_b32 v100, v165, v161, s58
    v_perm_b32 v101, v173, v169, s58
    v_perm_b32 v102, v181, v177, s58
    v_perm_b32 v103, v189, v185, s58
    v_mfma_f32_16x16x32_bf16 v[72:75], v[96:99], v[36:39], v[72:75]
    v_perm_b32 v96, v166, v162, s57
    v_perm_b32 v97, v174, v170, s57
    v_perm_b32 v98, v182, v178, s57
    v_perm_b32 v99, v190, v186, s57
    v_mfma_f32_16x16x32_bf16 v[76:79], v[100:103], v[36:39], v[76:79]
    v_perm_b32 v100, v166, v162, s58
    v_perm_b32 v101, v174, v170, s58
    v_perm_b32 v102, v182, v178, s58
    v_perm_b32 v103, v190, v186, s58
    v_mfma_f32_16x16x32_bf16 v[80:83], v[96:99], v[36:39], v[80:83]
    v_perm_b32 v96, v167, v163, s57
    v_perm_b32 v97, v175, v171, s57
    v_perm_b32 v98, v183, v179, s57
    v_perm_b32 v99, v191, v187, s57
    v_mfma_f32_16x16x32_bf16 v[84:87], v[100:103], v[36:39], v[84:87]
    v_perm_b32 v100, v167, v163, s58
    v_perm_b32 v101, v175, v171, s58
    v_perm_b32 v102, v183, v179, s58
    v_perm_b32 v103, v191, v187, s58
    v_mfma_f32_16x16x32_bf16 v[88:91], v[96:99], v[36:39], v[88:91]
    s_nop 0
    v_mfma_f32_16x16x32_bf16 v[92:95], v[100:103], v[36:39], v[92:95]
    s_add_u32 s42, s65, 131072
    buffer_load_dwordx4 v[192:195], v3, s[8:11], s42 offen offset:0 nt
    buffer_load_dwordx4 v[196:199], v3, s[8:11], s42 offen offset:1024 nt
    buffer_load_dwordx4 v[200:203], v3, s[8:11], s42 offen offset:2048 nt
    buffer_load_dwordx4 v[204:207], v3, s[8:11], s42 offen offset:3072 nt
    buffer_load_dwordx4 v[208:211], v4, s[8:11], s42 offen offset:0 nt
    buffer_load_dwordx4 v[212:215], v4, s[8:11], s42 offen offset:1024 nt
    buffer_load_dwordx4 v[216:219], v4, s[8:11], s42 offen offset:2048 nt
    buffer_load_dwordx4 v[220:223], v4, s[8:11], s42 offen offset:3072 nt
    s_barrier
    s_waitcnt vmcnt(0)
    v_perm_b32 v96, v196, v192, s57
    v_perm_b32 v97, v204, v200, s57
    v_perm_b32 v98, v212, v208, s57
    v_perm_b32 v99, v220, v216, s57
    v_perm_b32 v100, v196, v192, s58
    v_perm_b32 v101, v204, v200, s58
    v_perm_b32 v102, v212, v208, s58
    v_perm_b32 v103, v220, v216, s58
    v_mfma_f32_16x16x32_bf16 v[64:67], v[96:99], v[40:43], v[64:67]
    v_perm_b32 v96, v197, v193, s57
    v_perm_b32 v97, v205, v201, s57
    v_perm_b32 v98, v213, v209, s57
    v_perm_b32 v99, v221, v217, s57
    v_mfma_f32_16x16x32_bf16 v[68:71], v[100:103], v[40:43], v[68:71]
    v_perm_b32 v100, v197, v193, s58
    v_perm_b32 v101, v205, v201, s58
    v_perm_b32 v102, v213, v209, s58
    v_perm_b32 v103, v221, v217, s58
    v_mfma_f32_16x16x32_bf16 v[72:75], v[96:99], v[40:43], v[72:75]
    v_perm_b32 v96, v198, v194, s57
    v_perm_b32 v97, v206, v202, s57
    v_perm_b32 v98, v214, v210, s57
    v_perm_b32 v99, v222, v218, s57
    v_mfma_f32_16x16x32_bf16 v[76:79], v[100:103], v[40:43], v[76:79]
    v_perm_b32 v100, v198, v194, s58
    v_perm_b32 v101, v206, v202, s58
    v_perm_b32 v102, v214, v210, s58
    v_perm_b32 v103, v222, v218, s58
    v_mfma_f32_16x16x32_bf16 v[80:83], v[96:99], v[40:43], v[80:83]
    v_perm_b32 v96, v199, v195, s57
    v_perm_b32 v97, v207, v203, s57
    v_perm_b32 v98, v215, v211, s57
    v_perm_b32 v99, v223, v219, s57
    v_mfma_f32_16x16x32_bf16 v[84:87], v[100:103], v[40:43], v[84:87]
    v_perm_b32 v100, v199, v195, s58
    v_perm_b32 v101, v207, v203, s58
    v_perm_b32 v102, v215, v211, s58
    v_perm_b32 v103, v223, v219, s58
    v_mfma_f32_16x16x32_bf16 v[88:91], v[96:99], v[40:43], v[88:91]
    s_nop 0
    v_mfma_f32_16x16x32_bf16 v[92:95], v[100:103], v[40:43], v[92:95]
    s_add_u32 s42, s65, 196608
    buffer_load_dwordx4 v[224:227], v3, s[8:11], s42 offen offset:0 nt
    buffer_load_dwordx4 v[228:231], v3, s[8:11], s42 offen offset:1024 nt
    buffer_load_dwordx4 v[232:235], v3, s[8:11], s42 offen offset:2048 nt
    buffer_load_dwordx4 v[236:239], v3, s[8:11], s42 offen offset:3072 nt
    buffer_load_dwordx4 v[240:243], v4, s[8:11], s42 offen offset:0 nt
    buffer_load_dwordx4 v[244:247], v4, s[8:11], s42 offen offset:1024 nt
    buffer_load_dwordx4 v[248:251], v4, s[8:11], s42 offen offset:2048 nt
    buffer_load_dwordx4 v[252:255], v4, s[8:11], s42 offen offset:3072 nt
    s_barrier
    s_waitcnt vmcnt(0)
    s_cmp_eq_u32 s3, 2
    s_cbranch_scc0 Lnw_4
Lflchk:
    v_xor_b32 v5, s52, v108
    v_xor_b32 v6, s52, v109
    v_xor_b32 v7, s52, v110
    v_xor_b32 v8, s52, v111
    v_or3_b32 v5, v5, v6, v7
    v_or_b32 v5, v5, v8
    v_cmp_ne_u32 vcc, 0, v5
    s_cbranch_vccz Lnw_4
    s_sleep 16
    buffer_load_dwordx4 v[108:111], v3, s[12:15], 0 offen offset:1024 sc1
    s_waitcnt vmcnt(0)
    s_add_u32 s70, s70, 1
    s_cmp_lt_u32 s70, 131072
    s_cbranch_scc1 Lflchk
Lnw_4:
    v_perm_b32 v96, v228, v224, s57
    v_perm_b32 v97, v236, v232, s57
    v_perm_b32 v98, v244, v240, s57
    v_perm_b32 v99, v252, v248, s57
    v_perm_b32 v100, v228, v224, s58
    v_perm_b32 v101, v236, v232, s58
    v_perm_b32 v102, v244, v240, s58
    v_perm_b32 v103, v252, v248, s58
    v_mfma_f32_16x16x32_bf16 v[64:67], v[96:99], v[44:47], v[64:67]
    v_perm_b32 v96, v229, v225, s57
    v_perm_b32 v97, v237, v233, s57
    v_perm_b32 v98, v245, v241, s57
    v_perm_b32 v99, v253, v249, s57
    v_mfma_f32_16x16x32_bf16 v[68:71], v[100:103], v[44:47], v[68:71]
    v_perm_b32 v100, v229, v225, s58
    v_perm_b32 v101, v237, v233, s58
    v_perm_b32 v102, v245, v241, s58
    v_perm_b32 v103, v253, v249, s58
    v_mfma_f32_16x16x32_bf16 v[72:75], v[96:99], v[44:47], v[72:75]
    v_perm_b32 v96, v230, v226, s57
    v_perm_b32 v97, v238, v234, s57
    v_perm_b32 v98, v246, v242, s57
    v_perm_b32 v99, v254, v250, s57
    v_mfma_f32_16x16x32_bf16 v[76:79], v[100:103], v[44:47], v[76:79]
    v_perm_b32 v100, v230, v226, s58
    v_perm_b32 v101, v238, v234, s58
    v_perm_b32 v102, v246, v242, s58
    v_perm_b32 v103, v254, v250, s58
    v_mfma_f32_16x16x32_bf16 v[80:83], v[96:99], v[44:47], v[80:83]
    v_perm_b32 v96, v231, v227, s57
    v_perm_b32 v97, v239, v235, s57
    v_perm_b32 v98, v247, v243, s57
    v_perm_b32 v99, v255, v251, s57
    v_mfma_f32_16x16x32_bf16 v[84:87], v[100:103], v[44:47], v[84:87]
    v_perm_b32 v100, v231, v227, s58
    v_perm_b32 v101, v239, v235, s58
    v_perm_b32 v102, v247, v243, s58
    v_perm_b32 v103, v255, v251, s58
    v_mfma_f32_16x16x32_bf16 v[88:91], v[96:99], v[44:47], v[88:91]
    s_nop 0
    v_mfma_f32_16x16x32_bf16 v[92:95], v[100:103], v[44:47], v[92:95]
    s_add_u32 s42, s65, 262144
    buffer_load_dwordx4 v[128:131], v3, s[8:11], s42 offen offset:0 nt
    buffer_load_dwordx4 v[132:135], v3, s[8:11], s42 offen offset:1024 nt
    buffer_load_dwordx4 v[136:139], v3, s[8:11], s42 offen offset:2048 nt
    buffer_load_dwordx4 v[140:143], v3, s[8:11], s42 offen offset:3072 nt
    buffer_load_dwordx4 v[144:147], v4, s[8:11], s42 offen offset:0 nt
    buffer_load_dwordx4 v[148:151], v4, s[8:11], s42 offen offset:1024 nt
    buffer_load_dwordx4 v[152:155], v4, s[8:11], s42 offen offset:2048 nt
    buffer_load_dwordx4 v[156:159], v4, s[8:11], s42 offen offset:3072 nt
    s_barrier
    s_waitcnt vmcnt(0)
    v_perm_b32 v96, v132, v128, s57
    v_perm_b32 v97, v140, v136, s57
    v_perm_b32 v98, v148, v144, s57
    v_perm_b32 v99, v156, v152, s57
    v_perm_b32 v100, v132, v128, s58
    v_perm_b32 v101, v140, v136, s58
    v_perm_b32 v102, v148, v144, s58
    v_perm_b32 v103, v156, v152, s58
    v_mfma_f32_16x16x32_bf16 v[64:67], v[96:99], v[48:51], v[64:67]
    v_perm_b32 v96, v133, v129, s57
    v_perm_b32 v97, v141, v137, s57
    v_perm_b32 v98, v149, v145, s57
    v_perm_b32 v99, v157, v153, s57
    v_mfma_f32_16x16x32_bf16 v[68:71], v[100:103], v[48:51], v[68:71]
    v_perm_b32 v100, v133, v129, s58
    v_perm_b32 v101, v141, v137, s58
    v_perm_b32 v102, v149, v145, s58
    v_perm_b32 v103, v157, v153, s58
    v_mfma_f32_16x16x32_bf16 v[72:75], v[96:99], v[48:51], v[72:75]
    v_perm_b32 v96, v134, v130, s57
    v_perm_b32 v97, v142, v138, s57
    v_perm_b32 v98, v150, v146, s57
    v_perm_b32 v99, v158, v154, s57
    v_mfma_f32_16x16x32_bf16 v[76:79], v[100:103], v[48:51], v[76:79]
    v_perm_b32 v100, v134, v130, s58
    v_perm_b32 v101, v142, v138, s58
    v_perm_b32 v102, v150, v146, s58
    v_perm_b32 v103, v158, v154, s58
    v_mfma_f32_16x16x32_bf16 v[80:83], v[96:99], v[48:51], v[80:83]
    v_perm_b32 v96, v135, v131, s57
    v_perm_b32 v97, v143, v139, s57
    v_perm_b32 v98, v151, v147, s57
    v_perm_b32 v99, v159, v155, s57
    v_mfma_f32_16x16x32_bf16 v[84:87], v[100:103], v[48:51], v[84:87]
    v_perm_b32 v100, v135, v131, s58
    v_perm_b32 v101, v143, v139, s58
    v_perm_b32 v102, v151, v147, s58
    v_perm_b32 v103, v159, v155, s58
    v_mfma_f32_16x16x32_bf16 v[88:91], v[96:99], v[48:51], v[88:91]
    s_nop 0
    v_mfma_f32_16x16x32_bf16 v[92:95], v[100:103], v[48:51], v[92:95]
    s_add_u32 s42, s65, 327680
    buffer_load_dwordx4 v[160:163], v3, s[8:11], s42 offen offset:0 nt
    buffer_load_dwordx4 v[164:167], v3, s[8:11], s42 offen offset:1024 nt
    buffer_load_dwordx4 v[168:171], v3, s[8:11], s42 offen offset:2048 nt
    buffer_load_dwordx4 v[172:175], v3, s[8:11], s42 offen offset:3072 nt
    buffer_load_dwordx4 v[176:179], v4, s[8:11], s42 offen offset:0 nt
    buffer_load_dwordx4 v[180:183], v4, s[8:11], s42 offen offset:1024 nt
    buffer_load_dwordx4 v[184:187], v4, s[8:11], s42 offen offset:2048 nt
    buffer_load_dwordx4 v[188:191], v4, s[8:11], s42 offen offset:3072 nt
    s_barrier
    s_waitcnt vmcnt(0)
    v_perm_b32 v96, v164, v160, s57
    v_perm_b32 v97, v172, v168, s57
    v_perm_b32 v98, v180, v176, s57
    v_perm_b32 v99, v188, v184, s57
    v_perm_b32 v100, v164, v160, s58
    v_perm_b32 v101, v172, v168, s58
    v_perm_b32 v102, v180, v176, s58
    v_perm_b32 v103, v188, v184, s58
    v_mfma_f32_16x16x32_bf16 v[64:67], v[96:99], v[52:55], v[64:67]
    v_perm_b32 v96, v165, v161, s57
    v_perm_b32 v97, v173, v169, s57
    v_perm_b32 v98, v181, v177, s57
    v_perm_b32 v99, v189, v185, s57
    v_mfma_f32_16x16x32_bf16 v[68:71], v[100:103], v[52:55], v[68:71]
    v_perm_b32 v100, v165, v161, s58
    v_perm_b32 v101, v173, v169, s58
    v_perm_b32 v102, v181, v177, s58
    v_perm_b32 v103, v189, v185, s58
    v_mfma_f32_16x16x32_bf16 v[72:75], v[96:99], v[52:55], v[72:75]
    v_perm_b32 v96, v166, v162, s57
    v_perm_b32 v97, v174, v170, s57
    v_perm_b32 v98, v182, v178, s57
    v_perm_b32 v99, v190, v186, s57
    v_mfma_f32_16x16x32_bf16 v[76:79], v[100:103], v[52:55], v[76:79]
    v_perm_b32 v100, v166, v162, s58
    v_perm_b32 v101, v174, v170, s58
    v_perm_b32 v102, v182, v178, s58
    v_perm_b32 v103, v190, v186, s58
    v_mfma_f32_16x16x32_bf16 v[80:83], v[96:99], v[52:55], v[80:83]
    v_perm_b32 v96, v167, v163, s57
    v_perm_b32 v97, v175, v171, s57
    v_perm_b32 v98, v183, v179, s57
    v_perm_b32 v99, v191, v187, s57
    v_mfma_f32_16x16x32_bf16 v[84:87], v[100:103], v[52:55], v[84:87]
    v_perm_b32 v100, v167, v163, s58
    v_perm_b32 v101, v175, v171, s58
    v_perm_b32 v102, v183, v179, s58
    v_perm_b32 v103, v191, v187, s58
    v_mfma_f32_16x16x32_bf16 v[88:91], v[96:99], v[52:55], v[88:91]
    s_nop 0
    v_mfma_f32_16x16x32_bf16 v[92:95], v[100:103], v[52:55], v[92:95]
    s_add_u32 s42, s65, 393216
    buffer_load_dwordx4 v[192:195], v3, s[8:11], s42 offen offset:0 nt
    buffer_load_dwordx4 v[196:199], v3, s[8:11], s42 offen offset:1024 nt
    buffer_load_dwordx4 v[200:203], v3, s[8:11], s42 offen offset:2048 nt
    buffer_load_dwordx4 v[204:207], v3, s[8:11], s42 offen offset:3072 nt
    buffer_load_dwordx4 v[208:211], v4, s[8:11], s42 offen offset:0 nt
    buffer_load_dwordx4 v[212:215], v4, s[8:11], s42 offen offset:1024 nt
    buffer_load_dwordx4 v[216:219], v4, s[8:11], s42 offen offset:2048 nt
    buffer_load_dwordx4 v[220:223], v4, s[8:11], s42 offen offset:3072 nt
    s_barrier
    s_cmp_eq_u32 s3, 2
    s_cbranch_scc0 Lnw_5
    s_mov_b32 s44, s38
    s_mov_b32 s45, s39
    s_mov_b32 s46, 256
    s_mov_b32 s47, 0x20000
    v_mov_b32 v5, 0
    v_mov_b32 v117, 1
    s_mov_b64 exec, 1
    buffer_atomic_add v117, v5, s[44:47], 0 offen sc0 sc1
    s_mov_b64 exec, -1
Lnw_5:
    s_waitcnt vmcnt(0)
    v_perm_b32 v96, v196, v192, s57
    v_perm_b32 v97, v204, v200, s57
    v_perm_b32 v98, v212, v208, s57
    v_perm_b32 v99, v220, v216, s57
    v_perm_b32 v100, v196, v192, s58
    v_perm_b32 v101, v204, v200, s58
    v_perm_b32 v102, v212, v208, s58
    v_perm_b32 v103, v220, v216, s58
    v_mfma_f32_16x16x32_bf16 v[64:67], v[96:99], v[56:59], v[64:67]
    v_perm_b32 v96, v197, v193, s57
    v_perm_b32 v97, v205, v201, s57
    v_perm_b32 v98, v213, v209, s57
    v_perm_b32 v99, v221, v217, s57
    v_mfma_f32_16x16x32_bf16 v[68:71], v[100:103], v[56:59], v[68:71]
    v_perm_b32 v100, v197, v193, s58
    v_perm_b32 v101, v205, v201, s58
    v_perm_b32 v102, v213, v209, s58
    v_perm_b32 v103, v221, v217, s58
    v_mfma_f32_16x16x32_bf16 v[72:75], v[96:99], v[56:59], v[72:75]
    v_perm_b32 v96, v198, v194, s57
    v_perm_b32 v97, v206, v202, s57
    v_perm_b32 v98, v214, v210, s57
    v_perm_b32 v99, v222, v218, s57
    v_mfma_f32_16x16x32_bf16 v[76:79], v[100:103], v[56:59], v[76:79]
    v_perm_b32 v100, v198, v194, s58
    v_perm_b32 v101, v206, v202, s58
    v_perm_b32 v102, v214, v210, s58
    v_perm_b32 v103, v222, v218, s58
    v_mfma_f32_16x16x32_bf16 v[80:83], v[96:99], v[56:59], v[80:83]
    v_perm_b32 v96, v199, v195, s57
    v_perm_b32 v97, v207, v203, s57
    v_perm_b32 v98, v215, v211, s57
    v_perm_b32 v99, v223, v219, s57
    v_mfma_f32_16x16x32_bf16 v[84:87], v[100:103], v[56:59], v[84:87]
    v_perm_b32 v100, v199, v195, s58
    v_perm_b32 v101, v207, v203, s58
    v_perm_b32 v102, v215, v211, s58
    v_perm_b32 v103, v223, v219, s58
    v_mfma_f32_16x16x32_bf16 v[88:91], v[96:99], v[56:59], v[88:91]
    s_nop 0
    v_mfma_f32_16x16x32_bf16 v[92:95], v[100:103], v[56:59], v[92:95]
    s_add_u32 s42, s65, 458752
    buffer_load_dwordx4 v[224:227], v3, s[8:11], s42 offen offset:0 nt
    buffer_load_dwordx4 v[228:231], v3, s[8:11], s42 offen offset:1024 nt
    buffer_load_dwordx4 v[232:235], v3, s[8:11], s42 offen offset:2048 nt
    buffer_load_dwordx4 v[236:239], v3, s[8:11], s42 offen offset:3072 nt
    buffer_load_dwordx4 v[240:243], v4, s[8:11], s42 offen offset:0 nt
    buffer_load_dwordx4 v[244:247], v4, s[8:11], s42 offen offset:1024 nt
    buffer_load_dwordx4 v[248:251], v4, s[8:11], s42 offen offset:2048 nt
    buffer_load_dwordx4 v[252:255], v4, s[8:11], s42 offen offset:3072 nt
    s_barrier
    s_waitcnt vmcnt(0)
    s_cmp_eq_u32 s3, 2
    s_cbranch_scc0 Lnw_6
    v_mov_b32 v5, 23696
    s_mov_b64 exec, 1
    ds_write_b32 v5, v117
    s_mov_b64 exec, -1
Lnw_6:
    v_perm_b32 v96, v228, v224, s57
    v_perm_b32 v97, v236, v232, s57
    v_perm_b32 v98, v244, v240, s57
    v_perm_b32 v99, v252, v248, s57
    v_perm_b32 v100, v228, v224, s58
    v_perm_b32 v101, v236, v232, s58
    v_perm_b32 v102, v244, v240, s58
    v_perm_b32 v103, v252, v248, s58
    v_mfma_f32_16x16x32_bf16 v[64:67], v[96:99], v[60:63], v[64:67]
    v_perm_b32 v96, v229, v225, s57
    v_perm_b32 v97, v237, v233, s57
    v_perm_b32 v98, v245, v241, s57
    v_perm_b32 v99, v253, v249, s57
    v_mfma_f32_16x16x32_bf16 v[68:71], v[100:103], v[60:63], v[68:71]
    v_perm_b32 v100, v229, v225, s58
    v_perm_b32 v101, v237, v233, s58
    v_perm_b32 v102, v245, v241, s58
    v_perm_b32 v103, v253, v249, s58
    v_mfma_f32_16x16x32_bf16 v[72:75], v[96:99], v[60:63], v[72:75]
    v_perm_b32 v96, v230, v226, s57
    v_perm_b32 v97, v238, v234, s57
    v_perm_b32 v98, v246, v242, s57
    v_perm_b32 v99, v254, v250, s57
    v_mfma_f32_16x16x32_bf16 v[76:79], v[100:103], v[60:63], v[76:79]
    v_perm_b32 v100, v230, v226, s58
    v_perm_b32 v101, v238, v234, s58
    v_perm_b32 v102, v246, v242, s58
    v_perm_b32 v103, v254, v250, s58
    v_mfma_f32_16x16x32_bf16 v[80:83], v[96:99], v[60:63], v[80:83]
    v_perm_b32 v96, v231, v227, s57
    v_perm_b32 v97, v239, v235, s57
    v_perm_b32 v98, v247, v243, s57
    v_perm_b32 v99, v255, v251, s57
    v_mfma_f32_16x16x32_bf16 v[84:87], v[100:103], v[60:63], v[84:87]
    v_perm_b32 v100, v231, v227, s58
    v_perm_b32 v101, v239, v235, s58
    v_perm_b32 v102, v247, v243, s58
    v_perm_b32 v103, v255, v251, s58
    v_mfma_f32_16x16x32_bf16 v[88:91], v[96:99], v[60:63], v[88:91]
    s_nop 0
    v_mfma_f32_16x16x32_bf16 v[92:95], v[100:103], v[60:63], v[92:95]
    s_mov_b32 exec_lo, 0x000f000f
    s_mov_b32 exec_hi, 0x000f000f
    ds_write_b128 v118, v[64:67] offset:0
    ds_write_b128 v118, v[68:71] offset:256
    ds_write_b128 v118, v[72:75] offset:512
    ds_write_b128 v118, v[76:79] offset:768
    ds_write_b128 v118, v[80:83] offset:1024
    ds_write_b128 v118, v[84:87] offset:1280
    ds_write_b128 v118, v[88:91] offset:1536
    s_nop 0
    ds_write_b128 v118, v[92:95] offset:1792
    s_mov_b64 exec, -1
    s_waitcnt lgkmcnt(0)
    s_barrier
    s_cmp_lt_u32 s3, 2
    s_cbranch_scc0 Lnored
    ds_read_b128 v[96:99], v120
    ds_read_b128 v[100:103], v120 offset:16
    ds_read_b128 v[128:131], v119 offset:0
    ds_read_b128 v[132:135], v119 offset:2080
    ds_read_b128 v[136:139], v119 offset:4160
    ds_read_b128 v[140:143], v119 offset:6240
    ds_read_b128 v[144:147], v119 offset:8320
    ds_read_b128 v[148:151], v119 offset:10400
    ds_read_b128 v[152:155], v119 offset:12480
    ds_read_b128 v[156:159], v119 offset:14560
    s_waitcnt lgkmcnt(7)
    v_pk_mul_f32 v[12:13], v[96:97], v[128:129] op_sel:[0,0] op_sel_hi:[0,1]
    v_pk_mul_f32 v[14:15], v[96:97], v[130:131] op_sel:[0,0] op_sel_hi:[0,1]
    s_waitcnt lgkmcnt(6)
    v_pk_fma_f32 v[12:13], v[96:97], v[132:133], v[12:13] op_sel:[1,0,0] op_sel_hi:[1,1,1]
    v_pk_fma_f32 v[14:15], v[96:97], v[134:135], v[14:15] op_sel:[1,0,0] op_sel_hi:[1,1,1]
    s_waitcnt lgkmcnt(5)
    v_pk_fma_f32 v[12:13], v[98:99], v[136:137], v[12:13] op_sel:[0,0,0] op_sel_hi:[0,1,1]
    v_pk_fma_f32 v[14:15], v[98:99], v[138:139], v[14:15] op_sel:[0,0,0] op_sel_hi:[0,1,1]
    s_waitcnt lgkmcnt(4)
    v_pk_fma_f32 v[12:13], v[98:99], v[140:141], v[12:13] op_sel:[1,0,0] op_sel_hi:[1,1,1]
    v_pk_fma_f32 v[14:15], v[98:99], v[142:143], v[14:15] op_sel:[1,0,0] op_sel_hi:[1,1,1]
    s_waitcnt lgkmcnt(3)
    v_pk_fma_f32 v[12:13], v[100:101], v[144:145], v[12:13] op_sel:[0,0,0] op_sel_hi:[0,1,1]
    v_pk_fma_f32 v[14:15], v[100:101], v[146:147], v[14:15] op_sel:[0,0,0] op_sel_hi:[0,1,1]
    s_waitcnt lgkmcnt(2)
    v_pk_fma_f32 v[12:13], v[100:101], v[148:149], v[12:13] op_sel:[1,0,0] op_sel_hi:[1,1,1]
    v_pk_fma_f32 v[14:15], v[100:101], v[150:151], v[14:15] op_sel:[1,0,0] op_sel_hi:[1,1,1]
    s_waitcnt lgkmcnt(1)
    v_pk_fma_f32 v[12:13], v[102:103], v[152:153], v[12:13] op_sel:[0,0,0] op_sel_hi:[0,1,1]
    v_pk_fma_f32 v[14:15], v[102:103], v[154:155], v[14:15] op_sel:[0,0,0] op_sel_hi:[0,1,1]
    s_waitcnt lgkmcnt(0)
    v_pk_fma_f32 v[12:13], v[102:103], v[156:157], v[12:13] op_sel:[1,0,0] op_sel_hi:[1,1,1]
    v_pk_fma_f32 v[14:15], v[102:103], v[158:159], v[14:15] op_sel:[1,0,0] op_sel_hi:[1,1,1]
    buffer_store_dwordx4 v[12:15], v121, s[12:15], s69 offen sc1
Lnored:
    v_mov_b32 v5, 23696
    ds_read_b32 v6, v5
    s_waitcnt lgkmcnt(0)
    v_readfirstlane_b32 s63, v6
    s_nop 3
    s_cmp_lt_u32 s63, 64
    s_cbranch_scc1 LroleH
    s_cmp_lt_u32 s63, 120
    s_cbranch_scc1 LroleF
    s_cmp_lt_u32 s63, 152
    s_cbranch_scc0 Lfin
    s_cmp_eq_u32 s3, 2
    s_cbranch_scc0 Lfin
    s_mov_b32 s44, s16
    s_mov_b32 s45, s17
    s_mov_b32 s46, 2048
    s_mov_b32 s47, 0x20000
    s_mov_b32 s48, s34
    s_mov_b32 s49, s35
    s_mov_b32 s50, 1024
    s_mov_b32 s51, 0x20000
    s_sub_u32 s66, s63, 120
    s_lshr_b32 s67, s66, 4
    s_and_b32 s43, s66, 15
    v_and_b32 v5, 7, v0
    v_lshlrev_b32 v6, 3, v5
    v_lshrrev_b32 v7, 5, v0
    v_lshl_add_u32 v6, v7, 2, v6
    s_lshl_b32 s42, s43, 6
    v_add_u32 v107, s42, v6
    s_lshl_b32 s42, s67, 10
    v_add_u32 v106, s42, v107
    buffer_load_dword v110, v106, s[44:47], 0 offen
    buffer_load_dword v111, v107, s[48:51], 0 offen
    v_lshrrev_b32 v6, 3, v0
    v_lshlrev_b32 v112, 12, v6
    v_lshl_add_u32 v112, v5, 4, v112
    s_lshl_b32 s42, s67, 11
    s_lshl_b32 s43, s43, 7
    s_add_u32 s42, s42, s43
    s_add_u32 s68, s42, 1048576
    s_lshl_b32 s42, s66, 13
    s_add_u32 s69, s42, 131072
    s_mov_b32 s44, s36
    s_mov_b32 s45, s37
    s_mov_b32 s46, 2048
    s_mov_b32 s47, 0x20000
LpollHO:
    buffer_load_dwordx4 v[8:11], v112, s[12:15], s68 offen sc1
    s_waitcnt vmcnt(0)
    v_max3_u32 v5, v8, v9, v10
    v_max_u32 v5, v5, v11
    v_cmp_eq_u32 vcc, -1, v5
    s_cbranch_vccz Lok_7
    s_sleep 2
    s_add_u32 s70, s70, 1
    s_cmp_lt_u32 s70, 131072
    s_cbranch_scc1 LpollHO
Lok_7:
    s_nop 1
    v_permlane32_swap_b32 v8, v10
    v_permlane32_swap_b32 v9, v11
    s_nop 0
    v_add_f32 v8, v8, v10
    v_add_f32 v9, v9, v11
    v_mov_b32 v10, v8
    v_mov_b32 v11, v9
    s_nop 1
    v_permlane16_swap_b32 v10, v8
    v_permlane16_swap_b32 v11, v9
    s_nop 0
    v_add_f32 v8, v8, v10
    v_add_f32 v9, v9, v11
    s_nop 0
    v_add_f32_dpp v8, v8, v8 row_ror:8 row_mask:0xf bank_mask:0xf
    v_add_f32_dpp v9, v9, v9 row_ror:8 row_mask:0xf bank_mask:0xf
    v_lshlrev_b32 v12, 16, v110
    v_and_b32 v13, 0xffff0000, v110
    v_add_f32 v8, v8, v12
    v_add_f32 v9, v9, v13
    v_cvt_pk_bf16_f32 v8, v8, v9
    v_lshlrev_b32 v12, 16, v111
    v_and_b32 v13, 0xffff0000, v111
    v_lshlrev_b32 v108, 16, v8
    v_and_b32 v109, 0xffff0000, v8
    v_add_f32 v108, v108, v12
    v_add_f32 v109, v109, v13
    s_add_u32 s72, s69, 1024
    s_add_u32 s73, s69, 2048
    s_add_u32 s74, s69, 3072
    s_add_u32 s75, s69, 4096
    s_add_u32 s76, s69, 5120
    s_add_u32 s77, s69, 6144
LpollF:
    buffer_load_dwordx4 v[128:131], v3, s[12:15], s69 offen sc1
    buffer_load_dwordx4 v[132:135], v3, s[12:15], s72 offen sc1
    buffer_load_dwordx4 v[136:139], v3, s[12:15], s73 offen sc1
    buffer_load_dwordx4 v[140:143], v3, s[12:15], s74 offen sc1
    buffer_load_dwordx4 v[144:147], v3, s[12:15], s75 offen sc1
    buffer_load_dwordx4 v[148:151], v3, s[12:15], s76 offen sc1
    buffer_load_dwordx4 v[152:155], v3, s[12:15], s77 offen sc1
    s_waitcnt vmcnt(0)
    v_max3_u32 v5, v128, v129, v130
    v_max3_u32 v5, v5, v131, v132
    v_max3_u32 v5, v5, v133, v134
    v_max3_u32 v5, v5, v135, v136
    v_max3_u32 v5, v5, v137, v138
    v_max3_u32 v5, v5, v139, v140
    v_max3_u32 v5, v5, v141, v142
    v_max3_u32 v5, v5, v143, v144
    v_max3_u32 v5, v5, v145, v146
    v_max3_u32 v5, v5, v147, v148
    v_max3_u32 v5, v5, v149, v150
    v_max3_u32 v5, v5, v151, v152
    v_max3_u32 v5, v5, v153, v154
    v_max_u32 v5, v5, v155
    v_cmp_eq_u32 vcc, -1, v5
    s_cbranch_vccz Lok_8
    s_add_u32 s70, s70, 1
    s_cmp_lt_u32 s70, 131072
    s_cbranch_scc1 LpollF
Lok_8:
    v_pk_add_f32 v[128:129], v[128:129], v[132:133]
    v_pk_add_f32 v[130:131], v[130:131], v[134:135]
    v_pk_add_f32 v[136:137], v[136:137], v[140:141]
    v_pk_add_f32 v[138:139], v[138:139], v[142:143]
    v_pk_add_f32 v[144:145], v[144:145], v[148:149]
    v_pk_add_f32 v[146:147], v[146:147], v[150:151]
    v_pk_add_f32 v[128:129], v[128:129], v[136:137]
    v_pk_add_f32 v[130:131], v[130:131], v[138:139]
    v_pk_add_f32 v[144:145], v[144:145], v[152:153]
    v_pk_add_f32 v[146:147], v[146:147], v[154:155]
    v_pk_add_f32 v[8:9], v[128:129], v[144:145]
    v_pk_add_f32 v[10:11], v[130:131], v[146:147]
    s_nop 1
    v_permlane32_swap_b32 v8, v10
    v_permlane32_swap_b32 v9, v11
    s_nop 0
    v_add_f32 v8, v8, v10
    v_add_f32 v9, v9, v11
    v_mov_b32 v10, v8
    v_mov_b32 v11, v9
    s_nop 1
    v_permlane16_swap_b32 v10, v8
    v_permlane16_swap_b32 v11, v9
    s_nop 0
    v_add_f32 v8, v8, v10
    v_add_f32 v9, v9, v11
    s_nop 0
    v_add_f32_dpp v8, v8, v8 row_ror:8 row_mask:0xf bank_mask:0xf
    v_add_f32_dpp v9, v9, v9 row_ror:8 row_mask:0xf bank_mask:0xf
    v_add_f32 v8, v8, v108
    v_add_f32 v9, v9, v109
    v_cvt_pk_bf16_f32 v8, v8, v9
    s_mov_b32 exec_lo, 0xff
    s_mov_b32 exec_hi, 0xff
    buffer_store_dword v8, v106, s[44:47], 0 offen
    s_mov_b64 exec, -1
    s_cmp_eq_u32 s63, 120
    s_cbranch_scc0 Lnoep
    v_mov_b32 v8, s52
    v_mov_b32 v9, 0
    s_mov_b64 exec, 1
    buffer_store_dword v8, v9, s[12:15], 0 offen sc1
    s_mov_b64 exec, -1
Lnoep:
    s_branch Lfin
LroleH:
    v_lshrrev_b32 v116, 4, v0
    v_lshlrev_b32 v116, 5, v116
    s_lshr_b32 s66, s63, 3
    s_lshl_b32 s42, s66, 9
    s_lshr_b32 s43, s3, 1
    s_lshl_b32 s43, s43, 3
    s_add_u32 s42, s42, s43
    s_add_u32 s72, s42, 53248
    s_add_u32 s73, s72, 4096
    buffer_load_dwordx2 v[32:33], v116, s[12:15], s72 offen offset:0 sc1
    buffer_load_dwordx2 v[34:35], v116, s[12:15], s72 offen offset:128 sc1
    buffer_load_dwordx2 v[36:37], v116, s[12:15], s72 offen offset:256 sc1
    buffer_load_dwordx2 v[38:39], v116, s[12:15], s72 offen offset:384 sc1
    buffer_load_dwordx2 v[40:41], v116, s[12:15], s73 offen offset:0 sc1
    buffer_load_dwordx2 v[42:43], v116, s[12:15], s73 offen offset:128 sc1
    buffer_load_dwordx2 v[44:45], v116, s[12:15], s73 offen offset:256 sc1
    buffer_load_dwordx2 v[46:47], v116, s[12:15], s73 offen offset:384 sc1
    s_mov_b32 s44, s24
    s_mov_b32 s45, s25
    s_mov_b32 s46, 4194304
    s_mov_b32 s47, 0x20000
    v_lshrrev_b32 v5, 3, v0
    v_lshlrev_b32 v5, 13, v5
    v_and_b32 v6, 7, v0
    v_lshl_add_u32 v5, v6, 4, v5
    s_and_b32 s43, s63, 7
    s_lshl_b32 s43, s43, 7
    v_add_u32 v5, s43, v5
    s_lshl_b32 s66, s66, 9
    s_lshr_b32 s42, s3, 1
    s_lshl_b32 s42, s42, 7
    s_add_u32 s66, s66, s42
    s_and_b32 s42, s3, 1
    s_lshl_b32 s42, s42, 2
    s_add_u32 s66, s66, s42
    s_lshl_b32 s66, s66, 10
    s_lshl_b32 s67, s3, 13
    s_add_u32 s67, s67, 32768
    s_add_u32 s42, s66, 0
    s_add_u32 s43, s67, 0
    s_mov_b32 m0, s43
    s_nop 0
    buffer_load_dwordx4 v5, s[44:47], s42 offen nt lds
    s_add_u32 s42, s66, 65536
    s_add_u32 s43, s67, 1024
    s_mov_b32 m0, s43
    s_nop 0
    buffer_load_dwordx4 v5, s[44:47], s42 offen nt lds
    s_add_u32 s42, s66, 1024
    s_add_u32 s43, s67, 2048
    s_mov_b32 m0, s43
    s_nop 0
    buffer_load_dwordx4 v5, s[44:47], s42 offen nt lds
    s_add_u32 s42, s66, 66560
    s_add_u32 s43, s67, 3072
    s_mov_b32 m0, s43
    s_nop 0
    buffer_load_dwordx4 v5, s[44:47], s42 offen nt lds
    s_add_u32 s42, s66, 2048
    s_add_u32 s43, s67, 4096
    s_mov_b32 m0, s43
    s_nop 0
    buffer_load_dwordx4 v5, s[44:47], s42 offen nt lds
    s_add_u32 s42, s66, 67584
    s_add_u32 s43, s67, 5120
    s_mov_b32 m0, s43
    s_nop 0
    buffer_load_dwordx4 v5, s[44:47], s42 offen nt lds
    s_add_u32 s42, s66, 3072
    s_add_u32 s43, s67, 6144
    s_mov_b32 m0, s43
    s_nop 0
    buffer_load_dwordx4 v5, s[44:47], s42 offen nt lds
    s_add_u32 s42, s66, 68608
    s_add_u32 s43, s67, 7168
    s_mov_b32 m0, s43
    s_nop 0
    buffer_load_dwordx4 v5, s[44:47], s42 offen nt lds
    v_lshrrev_b32 v5, 4, v0
    v_bfe_u32 v6, v0, 2, 2
    v_lshl_add_u32 v6, v5, 3, v6
    v_lshlrev_b32 v6, 7, v6
    v_and_b32 v7, 3, v0
    v_lshl_add_u32 v6, v7, 3, v6
    v_add_u32 v106, s67, v6
    s_lshr_b32 s66, s63, 3
    s_lshl_b32 s42, s66, 15
    s_lshl_b32 s43, s3, 12
    s_add_u32 s42, s42, s43
    s_add_u32 s68, s42, 393216
    s_add_u32 s69, s68, 0x40000
    s_mul_i32 s42, s3, 384
    s_add_u32 s42, s42, 28416
    v_and_b32 v6, 1, v5
    v_lshlrev_b32 v6, 7, v6
    v_and_b32 v7, 15, v0
    v_lshl_add_u32 v6, v7, 3, v6
    v_lshrrev_b32 v7, 5, v0
    v_lshl_add_u32 v6, v7, 2, v6
    v_add_u32 v112, s42, v6
    v_and_b32 v6, 1, v0
    v_lshlrev_b32 v7, 7, v6
    v_lshl_add_u32 v7, v5, 4, v7
    v_add_u32 v113, s42, v7
    v_lshlrev_b32 v7, 6, v6
    v_lshl_add_u32 v7, v5, 4, v7
    s_lshl_b32 s42, s3, 9
    s_add_u32 s42, s42, 24064
    v_add_u32 v107, s42, v7
    v_and_b32 v7, 31, v0
    v_lshlrev_b32 v7, 4, v7
    v_add_u32 v114, 24064, v7
    v_bfe_u32 v6, v0, 2, 1
    v_lshlrev_b32 v6, 11, v6
    v_bfe_u32 v7, v0, 3, 2
    v_lshl_add_u32 v6, v7, 6, v6
    v_and_b32 v7, 3, v0
    v_lshl_add_u32 v115, v7, 4, v6
    s_lshl_b32 s42, s66, 12
    s_and_b32 s43, s63, 7
    s_lshl_b32 s43, s43, 8
    s_add_u32 s42, s42, s43
    s_add_u32 s74, s42, 1048576
    s_mov_b32 s76, 0xffff0000
    s_mov_b32 s77, 0xffff0000
    s_waitcnt vmcnt(8)
LstchkH:
    v_max3_u32 v5, v32, v33, v34
    v_max3_u32 v5, v5, v35, v36
    v_max3_u32 v5, v5, v37, v38
    v_max3_u32 v5, v5, v39, v40
    v_max3_u32 v5, v5, v41, v42
    v_max3_u32 v5, v5, v43, v44
    v_max3_u32 v5, v5, v45, v46
    v_max_u32 v5, v5, v47
    v_cmp_eq_u32 vcc, -1, v5
    s_cbranch_vccz LstokH
    s_sleep 4
    buffer_load_dwordx2 v[32:33], v116, s[12:15], s72 offen offset:0 sc1
    buffer_load_dwordx2 v[34:35], v116, s[12:15], s72 offen offset:128 sc1
    buffer_load_dwordx2 v[36:37], v116, s[12:15], s72 offen offset:256 sc1
    buffer_load_dwordx2 v[38:39], v116, s[12:15], s72 offen offset:384 sc1
    buffer_load_dwordx2 v[40:41], v116, s[12:15], s73 offen offset:0 sc1
    buffer_load_dwordx2 v[42:43], v116, s[12:15], s73 offen offset:128 sc1
    buffer_load_dwordx2 v[44:45], v116, s[12:15], s73 offen offset:256 sc1
    buffer_load_dwordx2 v[46:47], v116, s[12:15], s73 offen offset:384 sc1
    s_waitcnt vmcnt(0)
    s_add_u32 s70, s70, 1
    s_cmp_lt_u32 s70, 131072
    s_cbranch_scc1 LstchkH
LstokH:
    v_max3_f32 v8, v32, v34, v36
    v_max_f32 v8, v8, v38
    v_max3_f32 v9, v40, v42, v44
    v_max_f32 v9, v9, v46
    v_mov_b32 v10, v8
    v_mov_b32 v11, v9
    s_nop 1
    v_permlane16_swap_b32 v10, v8
    v_permlane16_swap_b32 v11, v9
    s_nop 0
    v_max_f32 v8, v8, v10
    v_max_f32 v9, v9, v11
    v_mov_b32 v10, v8
    v_mov_b32 v11, v9
    s_nop 1
    v_permlane32_swap_b32 v10, v8
    v_permlane32_swap_b32 v11, v9
    s_nop 0
    v_max_f32 v8, v8, v10
    v_max_f32 v9, v9, v11
    v_sub_f32 v32, v32, v8
    v_sub_f32 v34, v34, v8
    v_sub_f32 v36, v36, v8
    v_sub_f32 v38, v38, v8
    v_sub_f32 v40, v40, v9
    v_sub_f32 v42, v42, v9
    v_sub_f32 v44, v44, v9
    v_sub_f32 v46, v46, v9
    v_exp_f32 v32, v32
    v_exp_f32 v34, v34
    v_exp_f32 v36, v36
    v_exp_f32 v38, v38
    v_exp_f32 v40, v40
    v_exp_f32 v42, v42
    v_exp_f32 v44, v44
    v_exp_f32 v46, v46
    v_mul_f32 v8, v32, v33
    v_fmac_f32 v8, v34, v35
    v_fmac_f32 v8, v36, v37
    v_fmac_f32 v8, v38, v39
    v_mul_f32 v9, v40, v41
    v_fmac_f32 v9, v42, v43
    v_fmac_f32 v9, v44, v45
    v_fmac_f32 v9, v46, v47
    v_mov_b32 v10, v8
    v_mov_b32 v11, v9
    s_nop 1
    v_permlane16_swap_b32 v10, v8
    v_permlane16_swap_b32 v11, v9
    s_nop 0
    v_add_f32 v8, v8, v10
    v_add_f32 v9, v9, v11
    v_mov_b32 v10, v8
    v_mov_b32 v11, v9
    s_nop 1
    v_permlane32_swap_b32 v10, v8
    v_permlane32_swap_b32 v11, v9
    s_nop 0
    v_add_f32 v8, v8, v10
    v_add_f32 v9, v9, v11
    v_rcp_f32 v8, v8
    v_rcp_f32 v9, v9
    s_nop 0
    v_mul_f32 v96, v32, v8
    v_mul_f32 v97, v34, v8
    v_mul_f32 v98, v36, v8
    v_mul_f32 v99, v38, v8
    v_mul_f32 v100, v40, v9
    v_mul_f32 v101, v42, v9
    v_mul_f32 v102, v44, v9
    v_mul_f32 v103, v46, v9
    s_waitcnt vmcnt(0)
    ds_read_b64_tr_b16 v[128:129], v106 offset:0
    ds_read_b64_tr_b16 v[130:131], v106 offset:512
    ds_read_b64_tr_b16 v[132:133], v106 offset:32
    ds_read_b64_tr_b16 v[134:135], v106 offset:544
    ds_read_b64_tr_b16 v[136:137], v106 offset:64
    ds_read_b64_tr_b16 v[138:139], v106 offset:576
    ds_read_b64_tr_b16 v[140:141], v106 offset:96
    ds_read_b64_tr_b16 v[142:143], v106 offset:608
    s_waitcnt lgkmcnt(0)
    ds_read_b64_tr_b16 v[144:145], v106 offset:4096
    ds_read_b64_tr_b16 v[146:147], v106 offset:4608
    ds_read_b64_tr_b16 v[148:149], v106 offset:4128
    ds_read_b64_tr_b16 v[150:151], v106 offset:4640
    ds_read_b64_tr_b16 v[152:153], v106 offset:4160
    ds_read_b64_tr_b16 v[154:155], v106 offset:4672
    ds_read_b64_tr_b16 v[156:157], v106 offset:4192
    ds_read_b64_tr_b16 v[158:159], v106 offset:4704
    s_mov_b64 s[16:17], -1
    s_mov_b64 s[18:19], -1
    s_mov_b64 s[20:21], -1
    s_mov_b64 s[22:23], -1
    s_mov_b64 s[24:25], -1
    s_mov_b64 s[26:27], -1
    s_mov_b64 s[28:29], -1
    s_mov_b64 s[30:31], -1
LpollH:
    s_mov_b64 exec, s[16:17]
    s_cbranch_execz Lsk_9
    buffer_load_dwordx4 v[160:163], v3, s[12:15], s68 offen offset:0 sc1
Lsk_9:
    s_mov_b64 exec, s[18:19]
    s_cbranch_execz Lsk_10
    buffer_load_dwordx4 v[164:167], v3, s[12:15], s68 offen offset:1024 sc1
Lsk_10:
    s_mov_b64 exec, s[20:21]
    s_cbranch_execz Lsk_11
    buffer_load_dwordx4 v[168:171], v3, s[12:15], s68 offen offset:2048 sc1
Lsk_11:
    s_mov_b64 exec, s[22:23]
    s_cbranch_execz Lsk_12
    buffer_load_dwordx4 v[172:175], v3, s[12:15], s68 offen offset:3072 sc1
Lsk_12:
    s_mov_b64 exec, s[24:25]
    s_cbranch_execz Lsk_13
    buffer_load_dwordx4 v[176:179], v3, s[12:15], s69 offen offset:0 sc1
Lsk_13:
    s_mov_b64 exec, s[26:27]
    s_cbranch_execz Lsk_14
    buffer_load_dwordx4 v[180:183], v3, s[12:15], s69 offen offset:1024 sc1
Lsk_14:
    s_mov_b64 exec, s[28:29]
    s_cbranch_execz Lsk_15
    buffer_load_dwordx4 v[184:187], v3, s[12:15], s69 offen offset:2048 sc1
Lsk_15:
    s_mov_b64 exec, s[30:31]
    s_cbranch_execz Lsk_16
    buffer_load_dwordx4 v[188:191], v3, s[12:15], s69 offen offset:3072 sc1
Lsk_16:
    s_mov_b64 exec, -1
    s_waitcnt vmcnt(0)
    s_mov_b64 s[54:55], 0
    s_mov_b64 exec, s[16:17]
    s_cbranch_execz Lck_17
    v_max3_u32 v5, v160, v161, v162
    v_max_u32 v5, v5, v163
    v_cmp_eq_u32 s[16:17], -1, v5
    s_or_b64 s[54:55], s[54:55], s[16:17]
Lck_17:
    s_mov_b64 exec, s[18:19]
    s_cbranch_execz Lck_18
    v_max3_u32 v5, v164, v165, v166
    v_max_u32 v5, v5, v167
    v_cmp_eq_u32 s[18:19], -1, v5
    s_or_b64 s[54:55], s[54:55], s[18:19]
Lck_18:
    s_mov_b64 exec, s[20:21]
    s_cbranch_execz Lck_19
    v_max3_u32 v5, v168, v169, v170
    v_max_u32 v5, v5, v171
    v_cmp_eq_u32 s[20:21], -1, v5
    s_or_b64 s[54:55], s[54:55], s[20:21]
Lck_19:
    s_mov_b64 exec, s[22:23]
    s_cbranch_execz Lck_20
    v_max3_u32 v5, v172, v173, v174
    v_max_u32 v5, v5, v175
    v_cmp_eq_u32 s[22:23], -1, v5
    s_or_b64 s[54:55], s[54:55], s[22:23]
Lck_20:
    s_mov_b64 exec, s[24:25]
    s_cbranch_execz Lck_21
    v_max3_u32 v5, v176, v177, v178
    v_max_u32 v5, v5, v179
    v_cmp_eq_u32 s[24:25], -1, v5
    s_or_b64 s[54:55], s[54:55], s[24:25]
Lck_21:
    s_mov_b64 exec, s[26:27]
    s_cbranch_execz Lck_22
    v_max3_u32 v5, v180, v181, v182
    v_max_u32 v5, v5, v183
    v_cmp_eq_u32 s[26:27], -1, v5
    s_or_b64 s[54:55], s[54:55], s[26:27]
Lck_22:
    s_mov_b64 exec, s[28:29]
    s_cbranch_execz Lck_23
    v_max3_u32 v5, v184, v185, v186
    v_max_u32 v5, v5, v187
    v_cmp_eq_u32 s[28:29], -1, v5
    s_or_b64 s[54:55], s[54:55], s[28:29]
Lck_23:
    s_mov_b64 exec, s[30:31]
    s_cbranch_execz Lck_24
    v_max3_u32 v5, v188, v189, v190
    v_max_u32 v5, v5, v191
    v_cmp_eq_u32 s[30:31], -1, v5
    s_or_b64 s[54:55], s[54:55], s[30:31]
Lck_24:
    s_mov_b64 exec, -1
    s_cmp_eq_u64 s[54:55], 0
    s_cbranch_scc1 LgotH
    s_add_u32 s70, s70, 1
    s_cmp_lt_u32 s70, 131072
    s_cbranch_scc1 LpollH
LgotH:
    v_pk_mul_f32 v[8:9], v[96:97], v[160:161] op_sel:[0,0] op_sel_hi:[0,1]
    v_pk_mul_f32 v[10:11], v[96:97], v[162:163] op_sel:[0,0] op_sel_hi:[0,1]
    v_pk_mul_f32 v[12:13], v[100:101], v[176:177] op_sel:[0,0] op_sel_hi:[0,1]
    v_pk_mul_f32 v[14:15], v[100:101], v[178:179] op_sel:[0,0] op_sel_hi:[0,1]
    v_pk_fma_f32 v[8:9], v[96:97], v[164:165], v[8:9] op_sel:[1,0,0] op_sel_hi:[1,1,1]
    v_pk_fma_f32 v[10:11], v[96:97], v[166:167], v[10:11] op_sel:[1,0,0] op_sel_hi:[1,1,1]
    v_pk_fma_f32 v[12:13], v[100:101], v[180:181], v[12:13] op_sel:[1,0,0] op_sel_hi:[1,1,1]
    v_pk_fma_f32 v[14:15], v[100:101], v[182:183], v[14:15] op_sel:[1,0,0] op_sel_hi:[1,1,1]
    v_pk_fma_f32 v[8:9], v[98:99], v[168:169], v[8:9] op_sel:[0,0,0] op_sel_hi:[0,1,1]
    v_pk_fma_f32 v[10:11], v[98:99], v[170:171], v[10:11] op_sel:[0,0,0] op_sel_hi:[0,1,1]
    v_pk_fma_f32 v[12:13], v[102:103], v[184:185], v[12:13] op_sel:[0,0,0] op_sel_hi:[0,1,1]
    v_pk_fma_f32 v[14:15], v[102:103], v[186:187], v[14:15] op_sel:[0,0,0] op_sel_hi:[0,1,1]
    v_pk_fma_f32 v[8:9], v[98:99], v[172:173], v[8:9] op_sel:[1,0,0] op_sel_hi:[1,1,1]
    v_pk_fma_f32 v[10:11], v[98:99], v[174:175], v[10:11] op_sel:[1,0,0] op_sel_hi:[1,1,1]
    v_pk_fma_f32 v[12:13], v[102:103], v[188:189], v[12:13] op_sel:[1,0,0] op_sel_hi:[1,1,1]
    v_pk_fma_f32 v[14:15], v[102:103], v[190:191], v[14:15] op_sel:[1,0,0] op_sel_hi:[1,1,1]
    s_nop 1
    v_permlane32_swap_b32 v8, v10
    v_permlane32_swap_b32 v9, v11
    v_permlane32_swap_b32 v12, v14
    v_permlane32_swap_b32 v13, v15
    v_add_f32 v8, v8, v10
    v_add_f32 v9, v9, v11
    v_add_f32 v12, v12, v14
    v_add_f32 v13, v13, v15
    s_nop 0
    v_permlane16_swap_b32 v8, v12
    v_permlane16_swap_b32 v9, v13
    s_nop 0
    v_add_f32 v8, v8, v12
    v_add_f32 v9, v9, v13
    v_cvt_pk_bf16_f32 v8, v8, v9
    ds_write_b32 v112, v8
    s_waitcnt lgkmcnt(0)
    ds_read_b128 v[8:11], v113
    ds_read_b128 v[12:15], v113 offset:64
    s_waitcnt lgkmcnt(1)
    v_mfma_f32_16x16x32_bf16 v[32:35], v[128:131], v[8:11], 0
    v_mfma_f32_16x16x32_bf16 v[36:39], v[132:135], v[8:11], 0
    v_mfma_f32_16x16x32_bf16 v[40:43], v[136:139], v[8:11], 0
    v_mfma_f32_16x16x32_bf16 v[44:47], v[140:143], v[8:11], 0
    s_waitcnt lgkmcnt(0)
    v_mfma_f32_16x16x32_bf16 v[32:35], v[144:147], v[12:15], v[32:35]
    v_mfma_f32_16x16x32_bf16 v[36:39], v[148:151], v[12:15], v[36:39]
    v_mfma_f32_16x16x32_bf16 v[40:43], v[152:155], v[12:15], v[40:43]
    v_mfma_f32_16x16x32_bf16 v[44:47], v[156:159], v[12:15], v[44:47]
    s_mov_b32 exec_lo, 0x00030003
    s_mov_b32 exec_hi, 0x00030003
    s_nop 2
    ds_write_b128 v107, v[32:35] offset:0
    ds_write_b128 v107, v[36:39] offset:128
    ds_write_b128 v107, v[40:43] offset:256
    ds_write_b128 v107, v[44:47] offset:384
    s_mov_b64 exec, -1
    s_waitcnt lgkmcnt(0)
    s_barrier
    s_cmp_eq_u32 s3, 0
    s_cbranch_scc0 Lfin
    ds_read_b128 v[128:131], v114 offset:0
    ds_read_b128 v[132:135], v114 offset:512
    ds_read_b128 v[136:139], v114 offset:1024
    ds_read_b128 v[140:143], v114 offset:1536
    ds_read_b128 v[144:147], v114 offset:2048
    ds_read_b128 v[148:151], v114 offset:2560
    ds_read_b128 v[152:155], v114 offset:3072
    ds_read_b128 v[156:159], v114 offset:3584
    s_waitcnt lgkmcnt(4)
    v_pk_add_f32 v[128:129], v[128:129], v[132:133]
    v_pk_add_f32 v[130:131], v[130:131], v[134:135]
    v_pk_add_f32 v[136:137], v[136:137], v[140:141]
    v_pk_add_f32 v[138:139], v[138:139], v[142:143]
    v_pk_add_f32 v[128:129], v[128:129], v[136:137]
    v_pk_add_f32 v[130:131], v[130:131], v[138:139]
    s_waitcnt lgkmcnt(0)
    v_pk_add_f32 v[144:145], v[144:145], v[148:149]
    v_pk_add_f32 v[146:147], v[146:147], v[150:151]
    v_pk_add_f32 v[152:153], v[152:153], v[156:157]
    v_pk_add_f32 v[154:155], v[154:155], v[158:159]
    v_pk_add_f32 v[144:145], v[144:145], v[152:153]
    v_pk_add_f32 v[146:147], v[146:147], v[154:155]
    v_pk_add_f32 v[12:13], v[128:129], v[144:145]
    v_pk_add_f32 v[14:15], v[130:131], v[146:147]
    s_mov_b32 exec_lo, -1
    s_mov_b32 exec_hi, 0
    buffer_store_dwordx4 v[12:15], v115, s[12:15], s74 offen sc1
    s_mov_b64 exec, -1
    s_branch Lfin
LroleF:
    s_sub_u32 s64, s63, 64
    s_mov_b32 s44, s28
    s_mov_b32 s45, s29
    s_mov_b32 s46, 1835008
    s_mov_b32 s47, 0x20000
    s_mov_b32 s48, s32
    s_mov_b32 s49, s33
    s_mov_b32 s50, 1835008
    s_mov_b32 s51, 0x20000
    v_lshrrev_b32 v5, 2, v0
    v_mul_u32_u24 v5, 3584, v5
    v_and_b32 v6, 3, v0
    v_lshl_add_u32 v5, v6, 4, v5
    s_lshl_b32 s43, s64, 6
    v_add_u32 v5, s43, v5
    v_lshrrev_b32 v6, 3, v0
    v_lshlrev_b32 v6, 10, v6
    v_and_b32 v7, 7, v0
    v_lshl_add_u32 v6, v7, 4, v6
    s_mul_i32 s66, s3, 229376
    s_lshl_b32 s67, s3, 12
    s_add_u32 s67, s67, 32768
    s_add_u32 s42, s66, 0
    s_add_u32 s43, s67, 0
    s_mov_b32 m0, s43
    s_nop 0
    buffer_load_dwordx4 v5, s[44:47], s42 offen nt lds
    s_add_u32 s42, s66, 57344
    s_add_u32 s43, s67, 1024
    s_mov_b32 m0, s43
    s_nop 0
    buffer_load_dwordx4 v5, s[44:47], s42 offen nt lds
    s_add_u32 s42, s66, 114688
    s_add_u32 s43, s67, 2048
    s_mov_b32 m0, s43
    s_nop 0
    buffer_load_dwordx4 v5, s[44:47], s42 offen nt lds
    s_add_u32 s42, s66, 172032
    s_add_u32 s43, s67, 3072
    s_mov_b32 m0, s43
    s_nop 0
    buffer_load_dwordx4 v5, s[44:47], s42 offen nt lds
    s_lshl_b32 s66, s64, 15
    s_lshl_b32 s42, s3, 7
    s_add_u32 s66, s66, s42
    s_lshl_b32 s67, s3, 12
    s_add_u32 s67, s67, 98304
    s_add_u32 s42, s66, 0
    s_add_u32 s43, s67, 0
    s_mov_b32 m0, s43
    s_nop 0
    buffer_load_dwordx4 v6, s[48:51], s42 offen nt lds
    s_add_u32 s42, s66, 8192
    s_add_u32 s43, s67, 1024
    s_mov_b32 m0, s43
    s_nop 0
    buffer_load_dwordx4 v6, s[48:51], s42 offen nt lds
    s_add_u32 s42, s66, 16384
    s_add_u32 s43, s67, 2048
    s_mov_b32 m0, s43
    s_nop 0
    buffer_load_dwordx4 v6, s[48:51], s42 offen nt lds
    s_add_u32 s42, s66, 24576
    s_add_u32 s43, s67, 3072
    s_mov_b32 m0, s43
    s_nop 0
    buffer_load_dwordx4 v6, s[48:51], s42 offen nt lds
    s_mov_b32 s44, s30
    s_mov_b32 s45, s31
    s_mov_b32 s46, 3584
    s_mov_b32 s47, 0x20000
    s_mov_b32 s48, s16
    s_mov_b32 s49, s17
    s_mov_b32 s50, 2048
    s_mov_b32 s51, 0x20000
    v_and_b32 v5, 31, v0
    v_lshlrev_b32 v5, 1, v5
    s_lshl_b32 s42, s64, 6
    v_add_u32 v5, s42, v5
    v_and_b32 v6, 15, v0
    v_lshlrev_b32 v7, 3, v6
    v_lshrrev_b32 v8, 5, v0
    v_lshl_add_u32 v7, v8, 2, v7
    v_bfe_u32 v10, v0, 4, 1
    v_lshl_add_u32 v11, v10, 10, v7
    s_lshl_b32 s42, s3, 7
    v_add_u32 v11, s42, v11
    buffer_load_ushort v110, v5, s[44:47], 0 offen
    buffer_load_dword v113, v11, s[48:51], 0 offen
    s_mul_i32 s42, s3, 384
    s_add_u32 s42, s42, 28416
    v_lshl_add_u32 v114, v10, 7, v7
    v_add_u32 v114, s42, v114
    v_and_b32 v11, 1, v0
    v_lshlrev_b32 v11, 7, v11
    v_lshrrev_b32 v12, 4, v0
    v_lshl_add_u32 v11, v12, 4, v11
    v_add_u32 v115, s42, v11
    v_lshlrev_b32 v112, 12, v8
    v_lshl_add_u32 v112, v10, 11, v112
    v_lshl_add_u32 v112, v6, 4, v112
    s_lshl_b32 s42, s3, 8
    s_and_b32 s43, s64, 0
    s_lshl_b32 s43, s43, 15
    s_add_u32 s42, s42, s43
    s_add_u32 s68, s42, 1048576
    s_add_u32 s72, s68, 8192
    s_add_u32 s73, s68, 16384
    s_add_u32 s74, s68, 24576
    v_and_b32 v11, 1, v0
    v_lshlrev_b32 v11, 6, v11
    v_lshl_add_u32 v11, v12, 4, v11
    v_add_u32 v11, 23808, v11
    v_bfe_u32 v13, v0, 1, 3
    v_mov_b32 v14, 23936
    v_cmp_eq_u32 vcc, 0, v13
    s_nop 1
    v_cndmask_b32 v120, v14, v11, vcc
    v_cmp_eq_u32 vcc, 1, v13
    s_nop 1
    v_cndmask_b32 v121, v14, v11, vcc
    v_cmp_eq_u32 vcc, 2, v13
    s_nop 1
    v_cndmask_b32 v122, v14, v11, vcc
    v_cmp_eq_u32 vcc, 3, v13
    s_nop 1
    v_cndmask_b32 v123, v14, v11, vcc
    v_lshrrev_b32 v5, 4, v0
    v_bfe_u32 v6, v0, 2, 2
    v_lshl_add_u32 v6, v5, 3, v6
    v_and_b32 v7, 3, v0
    v_lshlrev_b32 v7, 3, v7
    v_lshl_add_u32 v8, v6, 6, v7
    v_lshl_add_u32 v9, v6, 7, v7
    s_lshl_b32 s42, s3, 12
    s_add_u32 s43, s42, 32768
    v_add_u32 v106, s43, v8
    s_add_u32 s43, s42, 98304
    v_add_u32 v9, s43, v9
    v_mov_b32 v116, 0x3f803f80
    v_mov_b32 v117, 0x3f803f80
    v_mov_b32 v118, 0x3f803f80
    v_mov_b32 v119, 0x3f803f80
    s_waitcnt vmcnt(0)
    ds_read_b64_tr_b16 v[128:129], v106 offset:0
    ds_read_b64_tr_b16 v[130:131], v106 offset:256
    ds_read_b64_tr_b16 v[132:133], v106 offset:32
    ds_read_b64_tr_b16 v[134:135], v106 offset:288
    ds_read_b64_tr_b16 v[136:137], v106 offset:2048
    ds_read_b64_tr_b16 v[138:139], v106 offset:2304
    ds_read_b64_tr_b16 v[140:141], v106 offset:2080
    ds_read_b64_tr_b16 v[142:143], v106 offset:2336
    s_waitcnt lgkmcnt(0)
    ds_read_b64_tr_b16 v[176:177], v9 offset:0
    ds_read_b64_tr_b16 v[178:179], v9 offset:512
    ds_read_b64_tr_b16 v[180:181], v9 offset:32
    ds_read_b64_tr_b16 v[182:183], v9 offset:544
    ds_read_b64_tr_b16 v[184:185], v9 offset:64
    ds_read_b64_tr_b16 v[186:187], v9 offset:576
    ds_read_b64_tr_b16 v[188:189], v9 offset:96
    ds_read_b64_tr_b16 v[190:191], v9 offset:608
    v_mfma_f32_16x16x32_bf16 v[144:147], v[116:119], v[128:131], 0
    v_mfma_f32_16x16x32_bf16 v[148:151], v[116:119], v[132:135], 0
    v_mfma_f32_16x16x32_bf16 v[144:147], v[116:119], v[136:139], v[144:147]
    v_mfma_f32_16x16x32_bf16 v[148:151], v[116:119], v[140:143], v[148:151]
    v_and_b32 v5, 15, v0
    v_lshlrev_b32 v5, 5, v5
    s_lshl_b32 s42, s3, 2
    s_add_u32 s42, s42, 24064
    v_add_u32 v107, s42, v5
    s_nop 3
    s_mov_b64 exec, 0xffff
    ds_write_b32 v107, v144 offset:2048
    ds_write_b32 v107, v148 offset:2560
    s_mov_b64 exec, -1
    s_waitcnt lgkmcnt(0)
    s_barrier
    v_and_b32 v5, 31, v0
    v_lshlrev_b32 v5, 5, v5
    v_add_u32 v5, 26112, v5
    ds_read_b128 v[96:99], v5
    ds_read_b128 v[100:103], v5 offset:16
    s_waitcnt lgkmcnt(0)
    v_pk_add_f32 v[96:97], v[96:97], v[98:99]
    v_pk_add_f32 v[100:101], v[100:101], v[102:103]
    v_pk_add_f32 v[96:97], v[96:97], v[100:101]
    v_add_f32 v96, v96, v97
    v_mov_b32 v111, v96
    v_lshlrev_b32 v110, 16, v110
    v_lshlrev_b32 v124, 16, v113
    v_and_b32 v125, 0xffff0000, v113
    v_and_b32 v5, 1, v0
    v_lshlrev_b32 v5, 4, v5
    v_bfe_u32 v6, v0, 2, 1
    v_add_u32 v5, v5, v6
    v_lshlrev_b32 v5, 13, v5
    v_bfe_u32 v6, v0, 1, 1
    v_lshl_add_u32 v5, v6, 6, v5
    v_lshrrev_b32 v6, 4, v0
    v_lshl_add_u32 v126, v6, 4, v5
    s_lshl_b32 s42, s3, 14
    s_lshl_b32 s43, s64, 7
    s_add_u32 s42, s42, s43
    s_add_u32 s75, s42, 131072
    v_mov_b32 v5, 27136
    s_lshl_b32 s42, s3, 2
    v_add_u32 v5, s42, v5
    v_lshl_add_u32 v127, v0, 5, v5
    v_lshlrev_b32 v5, 5, v0
    v_add_u32 v104, 24064, v5
    v_lshrrev_b32 v6, 5, v0
    v_lshlrev_b32 v7, 5, v6
    v_add_u32 v105, 27136, v7
    v_lshlrev_b32 v5, 6, v6
    v_and_b32 v6, 31, v0
    v_lshl_add_u32 v5, v6, 1, v5
    v_add_u32 v109, 23808, v5
    v_mov_b32 v192, 0xc0135761
    v_mov_b32 v193, 0xbdd2d3e8
    v_mov_b32 v194, 0x3b000000
    v_mov_b32 v195, 0x3727c5ac
    s_mov_b64 s[76:77], 2
LpollHF:
    buffer_load_dwordx4 v[160:163], v112, s[12:15], s68 offen sc1
    buffer_load_dwordx4 v[164:167], v112, s[12:15], s72 offen sc1
    buffer_load_dwordx4 v[168:171], v112, s[12:15], s73 offen sc1
    buffer_load_dwordx4 v[172:175], v112, s[12:15], s74 offen sc1
    s_waitcnt vmcnt(0)
    v_max3_u32 v5, v160, v161, v162
    v_max3_u32 v5, v5, v163, v164
    v_max3_u32 v5, v5, v165, v166
    v_max3_u32 v5, v5, v167, v168
    v_max3_u32 v5, v5, v169, v170
    v_max3_u32 v5, v5, v171, v172
    v_max3_u32 v5, v5, v173, v174
    v_max_u32 v5, v5, v175
    v_cmp_eq_u32 vcc, -1, v5
    s_cbranch_vccz Lok_25
    s_add_u32 s70, s70, 1
    s_cmp_lt_u32 s70, 131072
    s_cbranch_scc1 LpollHF
Lok_25:
    v_pk_add_f32 v[160:161], v[160:161], v[164:165]
    v_pk_add_f32 v[162:163], v[162:163], v[166:167]
    v_pk_add_f32 v[168:169], v[168:169], v[172:173]
    v_pk_add_f32 v[170:171], v[170:171], v[174:175]
    v_pk_add_f32 v[8:9], v[160:161], v[168:169]
    v_pk_add_f32 v[10:11], v[162:163], v[170:171]
    s_nop 1
    v_permlane32_swap_b32 v8, v10
    v_permlane32_swap_b32 v9, v11
    s_nop 0
    v_add_f32 v8, v8, v10
    v_add_f32 v9, v9, v11
    v_add_f32 v8, v8, v124
    v_add_f32 v9, v9, v125
    v_cvt_pk_bf16_f32 v8, v8, v9
    ds_write_b32 v114, v8
    s_waitcnt lgkmcnt(0)
    ds_read_b128 v[8:11], v115
    ds_read_b128 v[12:15], v115 offset:64
    s_waitcnt lgkmcnt(1)
    v_mfma_f32_16x16x32_bf16 v[152:155], v[8:11], v[128:131], 0
    v_mfma_f32_16x16x32_bf16 v[156:159], v[8:11], v[132:135], 0
    v_mfma_f32_16x16x32_bf16 v[160:163], v[8:11], v[116:119], 0
    v_mfma_f32_16x16x32_bf16 v[164:167], v[8:11], v[8:11], 0
    s_waitcnt lgkmcnt(0)
    v_mfma_f32_16x16x32_bf16 v[152:155], v[12:15], v[136:139], v[152:155]
    v_mfma_f32_16x16x32_bf16 v[156:159], v[12:15], v[140:143], v[156:159]
    v_mfma_f32_16x16x32_bf16 v[160:163], v[12:15], v[116:119], v[160:163]
    v_mfma_f32_16x16x32_bf16 v[164:167], v[12:15], v[12:15], v[164:167]
    s_mov_b64 exec, 0xffff
    s_nop 4
    ds_write_b32 v107, v152
    ds_write_b32 v107, v156 offset:512
    ds_write_b32 v107, v153 offset:1024
    ds_write_b32 v107, v157 offset:1536
    v_cndmask_b32 v160, v160, v161, s[76:77]
    v_cndmask_b32 v164, v164, v165, s[76:77]
    s_mov_b64 exec, 3
    ds_write_b32 v127, v160
    ds_write_b32 v127, v164 offset:64
    s_mov_b64 exec, -1
    s_waitcnt lgkmcnt(0)
    s_barrier
    s_cmp_eq_u32 s3, 0
    s_cbranch_scc0 LFskip
    ds_read_b128 v[128:131], v105
    ds_read_b128 v[132:135], v105 offset:16
    ds_read_b128 v[136:139], v105 offset:64
    ds_read_b128 v[140:143], v105 offset:80
    ds_read_b128 v[96:99], v104
    ds_read_b128 v[100:103], v104 offset:16
    s_waitcnt lgkmcnt(4)
    v_pk_add_f32 v[128:129], v[128:129], v[130:131]
    v_pk_add_f32 v[132:133], v[132:133], v[134:135]
    v_pk_add_f32 v[128:129], v[128:129], v[132:133]
    v_add_f32 v128, v128, v129
    s_waitcnt lgkmcnt(2)
    v_pk_add_f32 v[136:137], v[136:137], v[138:139]
    v_pk_add_f32 v[140:141], v[140:141], v[142:143]
    v_pk_add_f32 v[136:137], v[136:137], v[140:141]
    v_add_f32 v136, v136, v137
    v_mul_f32 v128, v194, v128
    v_mul_f32 v136, v194, v136
    v_fma_f32 v136, -v128, v128, v136
    v_max_f32 v136, 0, v136
    v_add_f32 v136, v195, v136
    v_rsq_f32 v136, v136
    s_waitcnt lgkmcnt(0)
    v_pk_add_f32 v[96:97], v[96:97], v[98:99]
    v_pk_add_f32 v[100:101], v[100:101], v[102:103]
    v_pk_add_f32 v[96:97], v[96:97], v[100:101]
    v_add_f32 v96, v96, v97
    v_fma_f32 v96, -v128, v111, v96
    v_fma_f32 v96, v96, v136, v110
    v_mul_f32 v97, v96, v96
    v_fma_f32 v97, v97, v193, v192
    v_mul_f32 v97, v97, v96
    v_exp_f32 v97, v97
    s_nop 0
    v_add_f32 v97, 1.0, v97
    v_rcp_f32 v97, v97
    s_nop 0
    v_mul_f32 v96, v96, v97
    s_nop 1
    v_mov_b32_dpp v97, v96 quad_perm:[1,0,3,2] row_mask:0xf bank_mask:0xf
    v_cvt_pk_bf16_f32 v96, v96, v97
    s_mov_b32 exec_lo, 0x55555555
    s_mov_b32 exec_hi, 0x55555555
    ds_write_b32 v109, v96
    s_mov_b64 exec, -1
    s_waitcnt lgkmcnt(0)
LFskip:
    s_barrier
    ds_read_b128 v[128:131], v120
    ds_read_b128 v[132:135], v121
    ds_read_b128 v[136:139], v122
    ds_read_b128 v[140:143], v123
    s_waitcnt lgkmcnt(3)
    v_mfma_f32_16x16x32_bf16 v[8:11], v[176:179], v[128:131], 0
    s_waitcnt lgkmcnt(2)
    v_mfma_f32_16x16x32_bf16 v[8:11], v[180:183], v[132:135], v[8:11]
    s_waitcnt lgkmcnt(1)
    v_mfma_f32_16x16x32_bf16 v[8:11], v[184:187], v[136:139], v[8:11]
    s_waitcnt lgkmcnt(0)
    v_mfma_f32_16x16x32_bf16 v[8:11], v[188:191], v[140:143], v[8:11]
    s_mov_b32 exec_lo, 0x00ff00ff
    s_mov_b32 exec_hi, 0x00ff00ff
    s_nop 5
    buffer_store_dwordx4 v[8:11], v126, s[12:15], s75 offen sc1
    s_mov_b64 exec, -1
Lfin:
Lend:
    s_endpgm

.section .rodata,"a"
.p2align 6
.amdhsa_kernel sequential_preLN__gqa_block_cached__dense_activation_gelu__decode_kernel
  .amdhsa_next_free_vgpr 256
  .amdhsa_next_free_sgpr 102
  .amdhsa_accum_offset 256
  .amdhsa_group_segment_fixed_size 0
  .amdhsa_float_denorm_mode_32 3
  .amdhsa_kernarg_size 104
  .amdhsa_user_sgpr_count 2
  .amdhsa_user_sgpr_kernarg_segment_ptr 1
  .amdhsa_system_sgpr_workgroup_id_x 1
.end_amdhsa_kernel
```
